```python
import torch

def _softmax(x, axis=-1):
    return torch.softmax(x, dim=axis)
def _gelu(x):
    return torch.nn.functional.gelu(x, approximate="tanh")
def _silu(x):
    return torch.nn.functional.silu(x)
def _sigmoid(x):
    return torch.sigmoid(x)
def _layernorm(x, axis=-1, eps=1e-5):
    m = x.mean(dim=axis, keepdim=True)
    v = x.var(dim=axis, keepdim=True, unbiased=False)
    return (x - m) / torch.sqrt(v + eps)
def _scatter_add(tgt, idx, src, axis=0):
    return tgt.clone().index_add_(axis, idx, src)
def _segment_sum(src, seg, n):
    out = torch.zeros((n,) + src.shape[1:], dtype=src.dtype)
    return out.index_add_(0, seg, src)
def _pad(x, pw):
    flat = tuple(v for pair in reversed(pw) for v in pair)
    return torch.nn.functional.pad(x, flat)

kernel_name = 'gated_mix__sliding_local_dilated__linear_attn_block__prompt'

def setup_inputs():

    _w = (lambda a: (lambda t: t.to(torch.bfloat16) if t.is_floating_point() else t)(torch.as_tensor(a)))
    def _A_setup():
        B, S, D = 1, 2048, 448
        return {
            "x": _w((lambda *s: torch.randn(*s, dtype=torch.bfloat16) * 0.05)(B, S, D)),
            "wqkv": _w((lambda *s: torch.randn(*s, dtype=torch.bfloat16) * 0.8)(D, 3 * D)),
            "wo": _w((lambda *s: torch.randn(*s, dtype=torch.bfloat16) * 0.05)(D, D)),
        }
    _A_in = _A_setup()

    def _B_setup():
        B, S, D = 1, 2048, 448
        return {
            "x": _w((lambda *s: torch.randn(*s, dtype=torch.bfloat16) * 0.05)(B, S, D)),
            "wqkv": _w((lambda *s: torch.randn(*s, dtype=torch.bfloat16) * 1.6)(D, 3 * D)),
            "wo": _w((lambda *s: torch.randn(*s, dtype=torch.bfloat16) * 0.4)(D, D)),
        }
    _B_in = _B_setup()

    return {
        "A_x": _A_in["x"],
        "A_wqkv": _A_in["wqkv"],
        "A_wo": _A_in["wo"],
        "B_x": _B_in["x"],
        "B_wqkv": _B_in["wqkv"],
        "B_wo": _B_in["wo"],
        "gate_w": _w((lambda *s: torch.randn(*s, dtype=torch.bfloat16) * 0.05)(448) * 16.0),
    }

def reference(A_x, A_wqkv, A_wo, B_x, B_wqkv, B_wo, gate_w):
    def _A_ref(x, wqkv, wo):
        B, S, D = x.shape
        H = 16; Dh = D // H
        W, dil = 8, 2
        qkv = (lambda x, *d: x.permute(*d))((x @ wqkv).reshape(B, S, 3, H, Dh), 2, 0, 3, 1, 4)
        q, k, v = qkv[0], qkv[1], qkv[2]
        scale = Dh ** -0.5
        pos = torch.arange(S)
        off = torch.arange(W) * dil
        idx = pos[:, None] - off[None, :]
        mask = idx >= 0
        idx_c = torch.where(mask, idx, 0).reshape(-1)
        kg = k[:, :, idx_c, :].reshape(B, H, S, W, Dh)
        vg = v[:, :, idx_c, :].reshape(B, H, S, W, Dh)
        logits = torch.einsum("bhsd,bhswd->bhsw", q, kg) * scale
        logits = torch.where(mask[None, None, :, :], logits, -1e9)
        attn = _softmax(logits, axis=-1)
        o = torch.einsum("bhsw,bhswd->bhsd", attn, vg)
        return (lambda x, *d: x.permute(*d))(o, 0, 2, 1, 3).reshape(B, S, D) @ wo

    def _B_ref(x, wqkv, wo):
        B, S, D = x.shape
        H = 16; Dh = D // H
        qkv = (lambda x, *d: x.permute(*d))((x @ wqkv).reshape(B, S, 3, H, Dh), 2, 0, 3, 1, 4)
        q, k, v = qkv[0], qkv[1], qkv[2]
        phi = lambda t: torch.where(t > 0, t + 1, torch.exp(t)) + 1e-6
        pq, pk = phi(q), phi(k)
        kv = torch.einsum("bhsd,bhse->bhde", pk, v)
        z = torch.einsum("bhsd->bhd", pk)
        num = torch.einsum("bhqd,bhde->bhqe", pq, kv)
        den = torch.einsum("bhqd,bhd->bhq", pq, z)[..., None] + 1e-6
        o = num / den
        return (lambda x, *d: x.permute(*d))(o, 0, 2, 1, 3).reshape(B, S, D) @ wo

    x = A_x
    g = _sigmoid((x * gate_w).sum(-1, keepdims=True))
    a = _A_ref(x, A_wqkv, A_wo)
    b = _B_ref(x, B_wqkv, B_wo)
    return g * a + (1 - g) * b
```

```asm
; @launch grid=(256,1,1) block=(512,1,1) lds=163840
.amdgcn_target "amdgcn-amd-amdhsa--gfx950"
.text
.globl gated_mix__sliding_local_dilated__linear_attn_block__prompt_kernel
.p2align 8
.type gated_mix__sliding_local_dilated__linear_attn_block__prompt_kernel,@function
gated_mix__sliding_local_dilated__linear_attn_block__prompt_kernel:
    s_cmp_ge_u32 s2, 256
    s_cbranch_scc1 L_end
    s_load_dwordx16 s[76:91], s[0:1], 0
    s_load_dwordx4 s[92:95], s[0:1], 64
    s_getpc_b64 s[66:67]
L_pc:
    s_cmp_ge_u32 s2, 32
    s_cbranch_scc1 L_nopf
    v_lshlrev_b32 v5, 6, v0
    v_min_u32 v5, L_end-L_pc, v5
    global_load_dword v23, v5, s[66:67]
L_nopf:
    v_lshrrev_b32 v4, 6, v0
    v_and_b32 v1, 63, v0
    v_readfirstlane_b32 s36, v4
    v_and_b32 v2, 15, v0
    v_bfe_u32 v3, v0, 4, 2
    s_and_b32 s44, s2, 7
    s_lshr_b32 s65, s2, 3
    s_lshr_b32 s46, s44, 1
    s_lshl_b32 s46, s46, 2
    s_and_b32 s45, s65, 3
    s_add_u32 s39, s46, s45
    s_and_b32 s63, s44, 1
    s_lshl_b32 s46, s63, 2
    s_lshr_b32 s62, s65, 2
    s_and_b32 s47, s62, 3
    s_add_u32 s40, s46, s47
    s_lshr_b32 s41, s65, 4
    s_mov_b32 s3, 0
    s_and_b32 s4, s36, 3
    s_lshr_b32 s6, s36, 2
    s_lshr_b32 s5, s4, 1
    s_and_b32 s38, s36, 1
    s_lshl_b32 s37, s5, 1
    s_add_u32 s37, s37, s6
    s_lshl_b32 s48, s36, 10
    s_cmp_eq_u32 s6, 0
    s_cbranch_scc1 L_compute
    s_lshl_b32 s49, s4, 12
    s_mul_i32 s50, s4, 6144
    v_lshrrev_b32 v4, 3, v1
    v_and_b32 v5, 7, v1
    v_xor_b32 v6, v5, v3
    s_lshl_b32 s44, s39, 7
    s_lshl_b32 s45, s4, 5
    s_add_u32 s44, s44, s45
    s_mul_i32 s44, s44, 896
    v_mul_u32_u24 v7, 896, v4
    v_lshl_add_u32 v7, v6, 4, v7
    v_add_u32 v10, s44, v7
    v_xor_b32 v8, 64, v7
    v_add_u32 v8, 6144, v8
    v_add_u32 v11, s44, v8
    v_and_b32 v6, 1, v3
    v_lshlrev_b32 v6, 1, v6
    v_xor_b32 v6, v5, v6
    v_xor_b32 v9, 4, v6
    v_min_u32 v6, 6, v6
    v_min_u32 v9, 6, v9
    s_mul_i32 s44, s4, 43008
    s_mul_i32 s45, s40, 112
    s_add_u32 s44, s44, s45
    v_mul_u32_u24 v12, 2688, v4
    v_add_u32 v12, s44, v12
    v_lshl_add_u32 v13, v9, 4, v12
    v_add_u32 v13, 21504, v13
    v_lshl_add_u32 v12, v6, 4, v12
    s_waitcnt lgkmcnt(0)
    s_mov_b32 s8, s76
    s_mov_b32 s9, s77
    s_mov_b32 s10, 1835008
    s_mov_b32 s11, 0x00020000
    s_cmp_eq_u32 s41, 1
    s_cselect_b32 s12, s78, s84
    s_cselect_b32 s13, s79, s85
    s_mov_b32 s14, 1204224
    s_mov_b32 s15, 0x00020000
    s_cbranch_scc0 L_ldB
    s_add_u32 m0, s49, 0
    s_mov_b32 s51, 0
    s_mov_b32 s53, 12288
    buffer_load_dwordx4 v10, s[8:11], s51 offen lds
    buffer_load_dwordx4 v11, s[8:11], s51 offen offset:1024 lds
    buffer_load_dwordx4 v10, s[8:11], s53 offen offset:2048 lds
    buffer_load_dwordx4 v11, s[8:11], s53 offen offset:3072 lds
    s_add_u32 m0, s50, 49152
    s_mov_b32 s52, 0
    buffer_load_dwordx4 v12, s[12:15], s52 offen lds
    s_add_u32 m0, s50, 49280
    s_mov_b32 s52, 0
    buffer_load_dwordx4 v12, s[12:15], s52 offen offset:896 lds
    s_add_u32 m0, s50, 49408
    s_mov_b32 s52, 0
    buffer_load_dwordx4 v12, s[12:15], s52 offen offset:1792 lds
    s_add_u32 m0, s50, 52224
    s_mov_b32 s52, 0
    buffer_load_dwordx4 v13, s[12:15], s52 offen lds
    s_add_u32 m0, s50, 52352
    s_mov_b32 s52, 0
    buffer_load_dwordx4 v13, s[12:15], s52 offen offset:896 lds
    s_add_u32 m0, s50, 52480
    s_mov_b32 s52, 0
    buffer_load_dwordx4 v13, s[12:15], s52 offen offset:1792 lds
    s_lshl_b32 s44, s39, 7
    s_sub_u32 s44, s44, 16
    s_mul_i32 s44, s44, 896
    v_add_u32 v14, s44, v7
    v_add_u32 v15, s44, v8
    s_lshl_b32 s46, s4, 11
    s_lshl_b32 s45, s4, 7
    s_add_u32 s47, s45, 512
    s_add_u32 m0, s46, 122880
    s_cmp_eq_u32 s39, 0
    s_cselect_b32 s45, 0, s45
    s_cselect_b32 s47, 0, s47
    buffer_load_dwordx4 v14, s[8:11], s45 offen lds
    buffer_load_dwordx4 v15, s[8:11], s45 offen offset:1024 lds
    s_cmp_eq_u32 s4, 3
    s_cbranch_scc1 L_ld_sided
    s_add_u32 m0, s46, 131072
    s_nop 0
    buffer_load_dwordx4 v14, s[8:11], s47 offen lds
    buffer_load_dwordx4 v15, s[8:11], s47 offen offset:1024 lds
L_ld_sided:
    s_add_u32 m0, s49, 16384
    s_mov_b32 s51, 128
    s_mov_b32 s53, 12416
    buffer_load_dwordx4 v10, s[8:11], s51 offen lds
    buffer_load_dwordx4 v11, s[8:11], s51 offen offset:1024 lds
    buffer_load_dwordx4 v10, s[8:11], s53 offen offset:2048 lds
    buffer_load_dwordx4 v11, s[8:11], s53 offen offset:3072 lds
    s_add_u32 m0, s50, 73728
    s_mov_b32 s52, 172032
    buffer_load_dwordx4 v12, s[12:15], s52 offen lds
    s_add_u32 m0, s50, 73856
    s_mov_b32 s52, 172032
    buffer_load_dwordx4 v12, s[12:15], s52 offen offset:896 lds
    s_add_u32 m0, s50, 73984
    s_mov_b32 s52, 172032
    buffer_load_dwordx4 v12, s[12:15], s52 offen offset:1792 lds
    s_add_u32 m0, s50, 76800
    s_mov_b32 s52, 172032
    buffer_load_dwordx4 v13, s[12:15], s52 offen lds
    s_add_u32 m0, s50, 76928
    s_mov_b32 s52, 172032
    buffer_load_dwordx4 v13, s[12:15], s52 offen offset:896 lds
    s_add_u32 m0, s50, 77056
    s_mov_b32 s52, 172032
    buffer_load_dwordx4 v13, s[12:15], s52 offen offset:1792 lds
    s_mov_b32 s16, s94
    s_mov_b32 s17, s95
    s_mov_b32 s18, 8388608
    s_mov_b32 s19, 0x00020000
    s_load_dwordx2 s[42:43], s[94:95], 0
    s_mov_b32 s20, s80
    s_mov_b32 s21, s81
    s_mov_b32 s22, 401408
    s_mov_b32 s23, 0x00020000
    s_mov_b32 s24, s86
    s_mov_b32 s25, s87
    s_mov_b32 s26, 401408
    s_mov_b32 s27, 0x00020000
    s_mov_b32 s28, s90
    s_mov_b32 s29, s91
    s_mov_b32 s30, 1835008
    s_mov_b32 s31, 0x00020000
    s_mov_b32 s32, s88
    s_mov_b32 s33, s89
    s_mov_b32 s34, 896
    s_mov_b32 s35, 0x00020000
    s_waitcnt vmcnt(10) lgkmcnt(0)
    s_barrier
    s_add_u32 s42, s42, 0x7f4a7c15
    s_addc_u32 s43, s43, 0x9e3779b9
    s_add_u32 m0, s49, 32768
    s_mov_b32 s51, 256
    s_mov_b32 s53, 12544
    buffer_load_dwordx4 v10, s[8:11], s51 offen lds
    buffer_load_dwordx4 v11, s[8:11], s51 offen offset:1024 lds
    buffer_load_dwordx4 v10, s[8:11], s53 offen offset:2048 lds
    buffer_load_dwordx4 v11, s[8:11], s53 offen offset:3072 lds
    s_add_u32 m0, s50, 98304
    s_mov_b32 s52, 344064
    buffer_load_dwordx4 v12, s[12:15], s52 offen lds
    s_add_u32 m0, s50, 98432
    s_mov_b32 s52, 344064
    buffer_load_dwordx4 v12, s[12:15], s52 offen offset:896 lds
    s_add_u32 m0, s50, 98560
    s_mov_b32 s52, 344064
    buffer_load_dwordx4 v12, s[12:15], s52 offen offset:1792 lds
    s_add_u32 m0, s50, 101376
    s_mov_b32 s52, 344064
    buffer_load_dwordx4 v13, s[12:15], s52 offen lds
    s_add_u32 m0, s50, 101504
    s_mov_b32 s52, 344064
    buffer_load_dwordx4 v13, s[12:15], s52 offen offset:896 lds
    s_add_u32 m0, s50, 101632
    s_mov_b32 s52, 344064
    buffer_load_dwordx4 v13, s[12:15], s52 offen offset:1792 lds
    s_waitcnt vmcnt(10)
    s_barrier
    s_add_u32 m0, s49, 0
    s_mov_b32 s51, 384
    s_mov_b32 s53, 12672
    buffer_load_dwordx4 v10, s[8:11], s51 offen lds
    buffer_load_dwordx4 v11, s[8:11], s51 offen offset:1024 lds
    buffer_load_dwordx4 v10, s[8:11], s53 offen offset:2048 lds
    buffer_load_dwordx4 v11, s[8:11], s53 offen offset:3072 lds
    s_add_u32 m0, s50, 49152
    s_mov_b32 s52, 516096
    buffer_load_dwordx4 v12, s[12:15], s52 offen lds
    s_add_u32 m0, s50, 49280
    s_mov_b32 s52, 516096
    buffer_load_dwordx4 v12, s[12:15], s52 offen offset:896 lds
    s_add_u32 m0, s50, 49408
    s_mov_b32 s52, 516096
    buffer_load_dwordx4 v12, s[12:15], s52 offen offset:1792 lds
    s_add_u32 m0, s50, 52224
    s_mov_b32 s52, 516096
    buffer_load_dwordx4 v13, s[12:15], s52 offen lds
    s_add_u32 m0, s50, 52352
    s_mov_b32 s52, 516096
    buffer_load_dwordx4 v13, s[12:15], s52 offen offset:896 lds
    s_add_u32 m0, s50, 52480
    s_mov_b32 s52, 516096
    buffer_load_dwordx4 v13, s[12:15], s52 offen offset:1792 lds
    s_waitcnt vmcnt(10)
    s_barrier
    s_add_u32 m0, s49, 16384
    s_mov_b32 s51, 512
    s_mov_b32 s53, 12800
    buffer_load_dwordx4 v10, s[8:11], s51 offen lds
    buffer_load_dwordx4 v11, s[8:11], s51 offen offset:1024 lds
    buffer_load_dwordx4 v10, s[8:11], s53 offen offset:2048 lds
    buffer_load_dwordx4 v11, s[8:11], s53 offen offset:3072 lds
    s_add_u32 m0, s50, 73728
    s_mov_b32 s52, 688128
    buffer_load_dwordx4 v12, s[12:15], s52 offen lds
    s_add_u32 m0, s50, 73856
    s_mov_b32 s52, 688128
    buffer_load_dwordx4 v12, s[12:15], s52 offen offset:896 lds
    s_add_u32 m0, s50, 73984
    s_mov_b32 s52, 688128
    buffer_load_dwordx4 v12, s[12:15], s52 offen offset:1792 lds
    s_add_u32 m0, s50, 76800
    s_mov_b32 s52, 688128
    buffer_load_dwordx4 v13, s[12:15], s52 offen lds
    s_add_u32 m0, s50, 76928
    s_mov_b32 s52, 688128
    buffer_load_dwordx4 v13, s[12:15], s52 offen offset:896 lds
    s_add_u32 m0, s50, 77056
    s_mov_b32 s52, 688128
    buffer_load_dwordx4 v13, s[12:15], s52 offen offset:1792 lds
    s_waitcnt vmcnt(10)
    s_barrier
    s_add_u32 m0, s49, 32768
    s_mov_b32 s51, 640
    s_mov_b32 s53, 12928
    buffer_load_dwordx4 v10, s[8:11], s51 offen lds
    buffer_load_dwordx4 v11, s[8:11], s51 offen offset:1024 lds
    buffer_load_dwordx4 v10, s[8:11], s53 offen offset:2048 lds
    buffer_load_dwordx4 v11, s[8:11], s53 offen offset:3072 lds
    s_add_u32 m0, s50, 98304
    s_mov_b32 s52, 860160
    buffer_load_dwordx4 v12, s[12:15], s52 offen lds
    s_add_u32 m0, s50, 98432
    s_mov_b32 s52, 860160
    buffer_load_dwordx4 v12, s[12:15], s52 offen offset:896 lds
    s_add_u32 m0, s50, 98560
    s_mov_b32 s52, 860160
    buffer_load_dwordx4 v12, s[12:15], s52 offen offset:1792 lds
    s_add_u32 m0, s50, 101376
    s_mov_b32 s52, 860160
    buffer_load_dwordx4 v13, s[12:15], s52 offen lds
    s_add_u32 m0, s50, 101504
    s_mov_b32 s52, 860160
    buffer_load_dwordx4 v13, s[12:15], s52 offen offset:896 lds
    s_add_u32 m0, s50, 101632
    s_mov_b32 s52, 860160
    buffer_load_dwordx4 v13, s[12:15], s52 offen offset:1792 lds
    s_waitcnt vmcnt(10)
    s_barrier
    s_add_u32 m0, s49, 0
    s_mov_b32 s51, 768
    s_mov_b32 s53, 13056
    buffer_load_dwordx4 v10, s[8:11], s51 offen lds
    buffer_load_dwordx4 v11, s[8:11], s51 offen offset:1024 lds
    buffer_load_dwordx4 v10, s[8:11], s53 offen offset:2048 lds
    buffer_load_dwordx4 v11, s[8:11], s53 offen offset:3072 lds
    s_add_u32 m0, s50, 49152
    s_mov_b32 s52, 1032192
    buffer_load_dwordx4 v12, s[12:15], s52 offen lds
    s_add_u32 m0, s50, 49280
    s_mov_b32 s52, 1032192
    buffer_load_dwordx4 v12, s[12:15], s52 offen offset:896 lds
    s_add_u32 m0, s50, 49408
    s_mov_b32 s52, 1032192
    buffer_load_dwordx4 v12, s[12:15], s52 offen offset:1792 lds
    s_add_u32 m0, s50, 52224
    s_mov_b32 s52, 1032192
    buffer_load_dwordx4 v13, s[12:15], s52 offen lds
    s_add_u32 m0, s50, 52352
    s_mov_b32 s52, 1032192
    buffer_load_dwordx4 v13, s[12:15], s52 offen offset:896 lds
    s_add_u32 m0, s50, 52480
    s_mov_b32 s52, 1032192
    buffer_load_dwordx4 v13, s[12:15], s52 offen offset:1792 lds
    s_and_b32 s44, s65, 15
    s_lshl_b32 s44, s44, 2
    s_add_u32 s44, s44, s4
    s_lshl_b32 s44, s44, 13
    v_lshlrev_b32 v14, 7, v1
    buffer_load_dword v23, v14, s[24:27], s44 offen
    s_mov_b32 s54, -1
    s_mov_b32 s55, 0xffff
    v_lshlrev_b32 v236, 4, v1
    v_lshlrev_b32 v237, 5, v2
    v_lshlrev_b32 v244, 2, v2
    s_lshl_b32 s44, s39, 1
    s_add_u32 s44, s44, 1
    s_sub_u32 s44, s44, s41
    s_lshl_b32 s44, s44, 2
    s_add_u32 s44, s44, s37
    s_lshl_b32 s45, s40, 1
    s_add_u32 s45, s45, s38
    s_lshl_b32 s46, s44, 5
    s_add_u32 s46, s46, s45
    s_lshl_b32 s46, s46, 10
    s_add_u32 s76, s46, 2097152
    s_lshl_b32 s46, s44, 4
    s_add_u32 s46, s46, s45
    s_lshl_b32 s46, s46, 5
    s_add_u32 s77, s46, 65536
    s_lshl_b32 s44, s39, 4
    s_add_u32 s44, s44, s36
    s_lshl_b32 s45, s44, 14
    s_add_u32 s79, s45, 2097152
    s_lshl_b32 s44, s39, 3
    s_lshr_b32 s45, s36, 1
    s_add_u32 s45, s45, s44
    s_lshl_b32 s45, s45, 9
    s_add_u32 s78, s45, 65536
    s_add_u32 s44, s44, s36
    s_lshl_b32 s44, s44, 6
    s_add_u32 s80, s44, 1572864
    v_lshrrev_b32 v4, 3, v1
    v_and_b32 v5, 7, v1
    v_lshlrev_b32 v6, 1, v3
    v_xor_b32 v6, v5, v6
    v_mul_u32_u24 v249, 896, v4
    s_mul_i32 s44, s36, 7168
    s_lshl_b32 s45, s40, 7
    s_add_u32 s44, s44, s45
    v_add_u32 v238, s44, v249
    v_lshl_add_u32 v238, v6, 4, v238
    v_lshl_add_u32 v249, v5, 4, v249
    s_lshl_b32 s44, s39, 3
    s_add_u32 s44, s44, s36
    s_mul_i32 s44, s44, 14336
    s_add_u32 s44, s44, s45
    v_add_u32 v249, s44, v249
    s_mul_i32 s44, s36, 2304
    s_add_u32 s44, s44, 115456
    v_mul_u32_u24 v246, 144, v4
    v_lshl_add_u32 v246, v5, 4, v246
    v_add_u32 v246, s44, v246
    v_mul_u32_u24 v245, 144, v2
    v_lshl_add_u32 v245, v3, 3, v245
    v_add_u32 v245, s44, v245
    v_lshrrev_b32 v4, 2, v2
    v_lshl_add_u32 v5, v3, 2, v4
    v_lshlrev_b32 v5, 7, v5
    v_and_b32 v6, 3, v2
    v_lshl_add_u32 v5, v6, 3, v5
    v_lshrrev_b32 v4, 1, v4
    v_and_b32 v6, 1, v3
    v_lshl_or_b32 v4, v6, 1, v4
    v_lshl_add_u32 v240, v4, 5, v5
    v_xor_b32 v241, 32, v240
    v_xor_b32 v242, 64, v240
    v_xor_b32 v243, 96, v240
    v_subrev_u32 v16, 28672, v238
    s_waitcnt vmcnt(11)
    s_barrier
    s_waitcnt vmcnt(1)
    s_barrier
    s_barrier
    v_subrev_u32 v16, 28672, v238
    s_barrier
    s_cmp_eq_u32 s40, 7
    s_cbranch_scc1 L_idle2
    s_add_u32 m0, s48, 0
    s_mov_b32 s46, 0
    buffer_load_dwordx4 v238, s[20:23], s46 offen lds
    s_add_u32 m0, s48, -4096
    s_mov_b32 s46, 0
    buffer_load_dwordx4 v16, s[20:23], s46 offen lds
    s_add_u32 m0, s48, 8192
    s_mov_b32 s46, 57344
    buffer_load_dwordx4 v238, s[20:23], s46 offen lds
    s_add_u32 m0, s48, 4096
    s_mov_b32 s46, 57344
    buffer_load_dwordx4 v16, s[20:23], s46 offen lds
    s_add_u32 m0, s48, 16384
    s_mov_b32 s46, 114688
    buffer_load_dwordx4 v238, s[20:23], s46 offen lds
    s_add_u32 m0, s48, 12288
    s_mov_b32 s46, 114688
    buffer_load_dwordx4 v16, s[20:23], s46 offen lds
    s_add_u32 m0, s48, 24576
    s_mov_b32 s46, 172032
    buffer_load_dwordx4 v238, s[20:23], s46 offen lds
    s_add_u32 m0, s48, 20480
    s_mov_b32 s46, 172032
    buffer_load_dwordx4 v16, s[20:23], s46 offen lds
    s_add_u32 m0, s48, 32768
    s_mov_b32 s46, 229376
    buffer_load_dwordx4 v238, s[20:23], s46 offen lds
    s_add_u32 m0, s48, 28672
    s_mov_b32 s46, 229376
    buffer_load_dwordx4 v16, s[20:23], s46 offen lds
    s_add_u32 m0, s48, 40960
    s_mov_b32 s46, 286720
    buffer_load_dwordx4 v238, s[20:23], s46 offen lds
    s_add_u32 m0, s48, 36864
    s_mov_b32 s46, 286720
    buffer_load_dwordx4 v16, s[20:23], s46 offen lds
    s_add_u32 m0, s48, 49152
    s_mov_b32 s46, 344064
    buffer_load_dwordx4 v238, s[20:23], s46 offen lds
    s_add_u32 m0, s48, 45056
    s_mov_b32 s46, 344064
    buffer_load_dwordx4 v16, s[20:23], s46 offen lds
    s_add_u32 m0, s48, 57344
    s_mov_b32 s46, 0
    buffer_load_dwordx4 v238, s[24:27], s46 offen lds
    s_add_u32 m0, s48, 53248
    s_mov_b32 s46, 0
    buffer_load_dwordx4 v16, s[24:27], s46 offen lds
    s_add_u32 m0, s48, 65536
    s_mov_b32 s46, 57344
    buffer_load_dwordx4 v238, s[24:27], s46 offen lds
    s_add_u32 m0, s48, 61440
    s_mov_b32 s46, 57344
    buffer_load_dwordx4 v16, s[24:27], s46 offen lds
    s_add_u32 m0, s48, 73728
    s_mov_b32 s46, 114688
    buffer_load_dwordx4 v238, s[24:27], s46 offen lds
    s_add_u32 m0, s48, 69632
    s_mov_b32 s46, 114688
    buffer_load_dwordx4 v16, s[24:27], s46 offen lds
    s_add_u32 m0, s48, 81920
    s_mov_b32 s46, 172032
    buffer_load_dwordx4 v238, s[24:27], s46 offen lds
    s_add_u32 m0, s48, 77824
    s_mov_b32 s46, 172032
    buffer_load_dwordx4 v16, s[24:27], s46 offen lds
    s_add_u32 m0, s48, 90112
    s_mov_b32 s46, 229376
    buffer_load_dwordx4 v238, s[24:27], s46 offen lds
    s_add_u32 m0, s48, 86016
    s_mov_b32 s46, 229376
    buffer_load_dwordx4 v16, s[24:27], s46 offen lds
    s_add_u32 m0, s48, 98304
    s_mov_b32 s46, 286720
    buffer_load_dwordx4 v238, s[24:27], s46 offen lds
    s_add_u32 m0, s48, 94208
    s_mov_b32 s46, 286720
    buffer_load_dwordx4 v16, s[24:27], s46 offen lds
    s_add_u32 m0, s48, 106496
    s_mov_b32 s46, 344064
    buffer_load_dwordx4 v238, s[24:27], s46 offen lds
    s_add_u32 m0, s48, 102400
    s_mov_b32 s46, 344064
    buffer_load_dwordx4 v16, s[24:27], s46 offen lds
    s_branch L_phase2
L_ldB:
    s_lshl_b32 s50, s4, 11
    s_add_u32 m0, s49, 0
    s_mov_b32 s51, 0
    s_mov_b32 s53, 12288
    buffer_load_dwordx4 v10, s[8:11], s51 offen lds
    buffer_load_dwordx4 v11, s[8:11], s51 offen offset:1024 lds
    buffer_load_dwordx4 v10, s[8:11], s53 offen offset:2048 lds
    buffer_load_dwordx4 v11, s[8:11], s53 offen offset:3072 lds
    s_add_u32 m0, s49, 113792
    s_mov_b32 s52, 0
    buffer_load_dwordx4 v12, s[12:15], s52 offen offset:896 lds
    s_add_u32 m0, s49, 113920
    s_mov_b32 s52, 0
    buffer_load_dwordx4 v12, s[12:15], s52 offen offset:1792 lds
    s_add_u32 m0, s49, 115840
    s_mov_b32 s52, 0
    buffer_load_dwordx4 v13, s[12:15], s52 offen offset:896 lds
    s_add_u32 m0, s49, 115968
    s_mov_b32 s52, 0
    buffer_load_dwordx4 v13, s[12:15], s52 offen offset:1792 lds
    s_add_u32 m0, s49, 16384
    s_mov_b32 s51, 128
    s_mov_b32 s53, 12416
    buffer_load_dwordx4 v10, s[8:11], s51 offen lds
    buffer_load_dwordx4 v11, s[8:11], s51 offen offset:1024 lds
    buffer_load_dwordx4 v10, s[8:11], s53 offen offset:2048 lds
    buffer_load_dwordx4 v11, s[8:11], s53 offen offset:3072 lds
    s_add_u32 m0, s49, 130176
    s_mov_b32 s52, 172032
    buffer_load_dwordx4 v12, s[12:15], s52 offen offset:896 lds
    s_add_u32 m0, s49, 130304
    s_mov_b32 s52, 172032
    buffer_load_dwordx4 v12, s[12:15], s52 offen offset:1792 lds
    s_add_u32 m0, s49, 132224
    s_mov_b32 s52, 172032
    buffer_load_dwordx4 v13, s[12:15], s52 offen offset:896 lds
    s_add_u32 m0, s49, 132352
    s_mov_b32 s52, 172032
    buffer_load_dwordx4 v13, s[12:15], s52 offen offset:1792 lds
    s_add_u32 m0, s49, 32768
    s_mov_b32 s51, 256
    s_mov_b32 s53, 12544
    buffer_load_dwordx4 v10, s[8:11], s51 offen lds
    buffer_load_dwordx4 v11, s[8:11], s51 offen offset:1024 lds
    buffer_load_dwordx4 v10, s[8:11], s53 offen offset:2048 lds
    buffer_load_dwordx4 v11, s[8:11], s53 offen offset:3072 lds
    s_mov_b32 s16, s94
    s_mov_b32 s17, s95
    s_mov_b32 s18, 8388608
    s_mov_b32 s19, 0x00020000
    s_load_dwordx2 s[42:43], s[94:95], 0
    s_mov_b32 s20, s80
    s_mov_b32 s21, s81
    s_mov_b32 s22, 401408
    s_mov_b32 s23, 0x00020000
    s_mov_b32 s24, s86
    s_mov_b32 s25, s87
    s_mov_b32 s26, 401408
    s_mov_b32 s27, 0x00020000
    s_mov_b32 s28, s90
    s_mov_b32 s29, s91
    s_mov_b32 s30, 1835008
    s_mov_b32 s31, 0x00020000
    s_mov_b32 s32, s88
    s_mov_b32 s33, s89
    s_mov_b32 s34, 896
    s_mov_b32 s35, 0x00020000
    s_waitcnt vmcnt(12) lgkmcnt(0)
    s_barrier
    s_add_u32 s42, s42, 0x7f4a7c15
    s_addc_u32 s43, s43, 0x9e3779b9
    s_add_u32 m0, s49, 49152
    s_mov_b32 s51, 384
    s_mov_b32 s53, 12672
    buffer_load_dwordx4 v10, s[8:11], s51 offen lds
    buffer_load_dwordx4 v11, s[8:11], s51 offen offset:1024 lds
    buffer_load_dwordx4 v10, s[8:11], s53 offen offset:2048 lds
    buffer_load_dwordx4 v11, s[8:11], s53 offen offset:3072 lds
    s_waitcnt vmcnt(8)
    s_barrier
    s_add_u32 m0, s49, 113792
    s_mov_b32 s52, 344064
    buffer_load_dwordx4 v12, s[12:15], s52 offen offset:896 lds
    s_add_u32 m0, s49, 113920
    s_mov_b32 s52, 344064
    buffer_load_dwordx4 v12, s[12:15], s52 offen offset:1792 lds
    s_add_u32 m0, s49, 115840
    s_mov_b32 s52, 344064
    buffer_load_dwordx4 v13, s[12:15], s52 offen offset:896 lds
    s_add_u32 m0, s49, 115968
    s_mov_b32 s52, 344064
    buffer_load_dwordx4 v13, s[12:15], s52 offen offset:1792 lds
    s_add_u32 m0, s49, 65536
    s_mov_b32 s51, 512
    s_mov_b32 s53, 12800
    buffer_load_dwordx4 v10, s[8:11], s51 offen lds
    buffer_load_dwordx4 v11, s[8:11], s51 offen offset:1024 lds
    buffer_load_dwordx4 v10, s[8:11], s53 offen offset:2048 lds
    buffer_load_dwordx4 v11, s[8:11], s53 offen offset:3072 lds
    s_waitcnt vmcnt(4)
    s_barrier
    s_add_u32 m0, s49, 130176
    s_mov_b32 s52, 516096
    buffer_load_dwordx4 v12, s[12:15], s52 offen offset:896 lds
    s_add_u32 m0, s49, 130304
    s_mov_b32 s52, 516096
    buffer_load_dwordx4 v12, s[12:15], s52 offen offset:1792 lds
    s_add_u32 m0, s49, 132224
    s_mov_b32 s52, 516096
    buffer_load_dwordx4 v13, s[12:15], s52 offen offset:896 lds
    s_add_u32 m0, s49, 132352
    s_mov_b32 s52, 516096
    buffer_load_dwordx4 v13, s[12:15], s52 offen offset:1792 lds
    s_add_u32 m0, s49, 81920
    s_mov_b32 s51, 640
    s_mov_b32 s53, 12928
    buffer_load_dwordx4 v10, s[8:11], s51 offen lds
    buffer_load_dwordx4 v11, s[8:11], s51 offen offset:1024 lds
    buffer_load_dwordx4 v10, s[8:11], s53 offen offset:2048 lds
    buffer_load_dwordx4 v11, s[8:11], s53 offen offset:3072 lds
    s_waitcnt vmcnt(4)
    s_barrier
    s_add_u32 m0, s49, 113792
    s_mov_b32 s52, 688128
    buffer_load_dwordx4 v12, s[12:15], s52 offen offset:896 lds
    s_add_u32 m0, s49, 113920
    s_mov_b32 s52, 688128
    buffer_load_dwordx4 v12, s[12:15], s52 offen offset:1792 lds
    s_add_u32 m0, s49, 115840
    s_mov_b32 s52, 688128
    buffer_load_dwordx4 v13, s[12:15], s52 offen offset:896 lds
    s_add_u32 m0, s49, 115968
    s_mov_b32 s52, 688128
    buffer_load_dwordx4 v13, s[12:15], s52 offen offset:1792 lds
    s_add_u32 m0, s49, 98304
    s_mov_b32 s51, 768
    s_mov_b32 s53, 13056
    buffer_load_dwordx4 v10, s[8:11], s51 offen lds
    buffer_load_dwordx4 v11, s[8:11], s51 offen offset:1024 lds
    buffer_load_dwordx4 v10, s[8:11], s53 offen offset:2048 lds
    buffer_load_dwordx4 v11, s[8:11], s53 offen offset:3072 lds
    s_cmp_lg_u32 s4, 0
    s_cbranch_scc1 L_gw_1
    v_lshlrev_b32 v14, 4, v1
    s_mov_b32 m0, 147456
    s_nop 0
    buffer_load_dwordx4 v14, s[32:35], 0 offen lds
L_gw_1:
    s_waitcnt vmcnt(4)
    s_barrier
    s_add_u32 m0, s49, 130176
    s_mov_b32 s52, 860160
    buffer_load_dwordx4 v12, s[12:15], s52 offen offset:896 lds
    s_add_u32 m0, s49, 130304
    s_mov_b32 s52, 860160
    buffer_load_dwordx4 v12, s[12:15], s52 offen offset:1792 lds
    s_add_u32 m0, s49, 132224
    s_mov_b32 s52, 860160
    buffer_load_dwordx4 v13, s[12:15], s52 offen offset:896 lds
    s_add_u32 m0, s49, 132352
    s_mov_b32 s52, 860160
    buffer_load_dwordx4 v13, s[12:15], s52 offen offset:1792 lds
    s_mov_b32 s54, -1
    s_mov_b32 s55, 0xffff
    v_lshlrev_b32 v236, 4, v1
    v_lshlrev_b32 v237, 5, v2
    v_lshlrev_b32 v244, 2, v2
    s_lshl_b32 s44, s39, 1
    s_add_u32 s44, s44, 1
    s_sub_u32 s44, s44, s41
    s_lshl_b32 s44, s44, 2
    s_add_u32 s44, s44, s37
    s_lshl_b32 s45, s40, 1
    s_add_u32 s45, s45, s38
    s_lshl_b32 s46, s44, 5
    s_add_u32 s46, s46, s45
    s_lshl_b32 s46, s46, 10
    s_add_u32 s76, s46, 2097152
    s_lshl_b32 s46, s44, 4
    s_add_u32 s46, s46, s45
    s_lshl_b32 s46, s46, 5
    s_add_u32 s77, s46, 65536
    s_mov_b32 s58, 0x10001000
    s_mov_b32 s59, 0x10001000
    s_mov_b32 s68, 1069066811
    s_mov_b32 s69, 1069066811
    s_mov_b32 s70, 897988541
    s_mov_b32 s71, 897988541
    s_lshl_b32 s44, s4, 11
    s_add_u32 s45, s44, 149504
    v_add_u32 v217, s45, v236
    s_xor_b32 s45, s44, 4096
    s_add_u32 s45, s45, 149504
    v_add_u32 v218, s45, v236
    v_mov_b32 v216, 161792
    s_lshl_b32 s45, s4, 2
    v_add_u32 v219, s45, v216
    s_lshl_b32 s45, s38, 2
    s_add_u32 s45, s45, 16
    v_add_u32 v223, s45, v216
    v_mov_b32 v250, 1
    s_lshl_b32 s44, s40, 2
    s_add_u32 s44, s44, s4
    s_lshl_b32 s45, s44, 14
    s_add_u32 s81, s45, 262144
    s_lshl_b32 s45, s44, 9
    s_add_u32 s83, s45, 4096
    s_lshl_b32 s45, s39, 5
    s_add_u32 s82, s83, s45
    s_lshl_b32 s44, s38, 11
    s_add_u32 s44, s44, 157696
    v_add_u32 v221, s44, v236
    s_lshl_b32 s45, s5, 3
    v_add_u32 v220, s45, v221
    v_lshlrev_b32 v222, 8, v3
    v_add_u32 v222, s44, v222
    s_lshl_b32 s44, s39, 2
    s_add_u32 s44, s44, s4
    s_lshl_b32 s44, s44, 7
    s_add_u32 s86, s44, 1572864
    v_lshrrev_b32 v4, 2, v2
    v_and_b32 v5, 1, v2
    v_lshlrev_b32 v5, 4, v5
    v_mov_b32 v6, 0x3f80
    v_lshlrev_b32 v5, v5, v6
    v_cmp_eq_u32 vcc, v4, v3
    v_and_b32 v6, 2, v2
    s_nop 0
    v_cndmask_b32 v5, 0, v5, vcc
    v_cmp_eq_u32 vcc, 0, v6
    v_mov_b32 v226, 0
    v_mov_b32 v227, 0
    v_mov_b32 v228, 0
    v_mov_b32 v229, 0
    v_cndmask_b32 v224, 0, v5, vcc
    v_cndmask_b32 v225, v5, 0, vcc
    v_mov_b32 v230, v224
    v_mov_b32 v231, v225
    v_mov_b32 v232, s70
    v_mov_b32 v233, s70
    v_mov_b32 v234, s70
    v_mov_b32 v235, s70
    v_lshrrev_b32 v9, 1, v2
    v_xor_b32 v9, v3, v9
    v_lshlrev_b32 v9, 4, v9
    v_lshl_add_u32 v9, v2, 7, v9
    s_lshl_b32 s45, s5, 13
    v_add_u32 v16, s45, v9
    v_xor_b32 v17, 64, v16
    v_add_u32 v18, 65536, v16
    v_add_u32 v19, 65536, v17
    v_and_b32 v4, 3, v2
    v_lshlrev_b32 v4, 3, v4
    s_mul_i32 s44, s38, 56
    v_add_u32 v4, s44, v4
    v_and_b32 v5, 8, v2
    v_lshlrev_b32 v5, 2, v5
    v_xor_b32 v4, v4, v5
    v_and_b32 v5, 1, v3
    v_lshlrev_b32 v5, 6, v5
    v_xor_b32 v4, v4, v5
    v_lshrrev_b32 v5, 2, v2
    v_lshl_add_u32 v4, v5, 7, v4
    v_mul_u32_u24 v5, 1024, v3
    v_add_u32 v4, v4, v5
    v_add_u32 v251, 114688, v4
    v_and_b32 v4, 3, v2
    v_lshlrev_b32 v4, 3, v4
    s_mul_i32 s44, s38, 56
    s_add_u32 s44, s44, 32
    v_add_u32 v4, s44, v4
    v_and_b32 v5, 8, v2
    v_lshlrev_b32 v5, 2, v5
    v_xor_b32 v4, v4, v5
    v_and_b32 v5, 1, v3
    v_lshlrev_b32 v5, 6, v5
    v_xor_b32 v4, v4, v5
    v_lshrrev_b32 v5, 2, v2
    v_lshl_add_u32 v4, v5, 7, v4
    v_mul_u32_u24 v5, 1024, v3
    v_add_u32 v4, v4, v5
    v_add_u32 v252, 114688, v4
    v_lshlrev_b32 v15, 4, v3
    v_add_u32 v15, 147456, v15
    s_waitcnt vmcnt(0)
    s_barrier
    s_add_u32 m0, s49, 113792
    s_mov_b32 s52, 1032192
    buffer_load_dwordx4 v12, s[12:15], s52 offen offset:896 lds
    s_add_u32 m0, s49, 113920
    s_mov_b32 s52, 1032192
    buffer_load_dwordx4 v12, s[12:15], s52 offen offset:1792 lds
    s_add_u32 m0, s49, 115840
    s_mov_b32 s52, 1032192
    buffer_load_dwordx4 v13, s[12:15], s52 offen offset:896 lds
    s_add_u32 m0, s49, 115968
    s_mov_b32 s52, 1032192
    buffer_load_dwordx4 v13, s[12:15], s52 offen offset:1792 lds
    s_and_b32 s44, s65, 15
    s_lshl_b32 s44, s44, 2
    s_add_u32 s44, s44, s4
    s_lshl_b32 s44, s44, 13
    v_lshlrev_b32 v14, 7, v1
    buffer_load_dword v23, v14, s[20:23], s44 offen
    s_waitcnt vmcnt(1)
    s_barrier
    s_add_u32 m0, s50, 131072
    s_mov_b32 s52, 0
    buffer_load_dwordx4 v12, s[12:15], s52 offen lds
    s_add_u32 m0, s50, 132096
    s_mov_b32 s52, 0
    buffer_load_dwordx4 v13, s[12:15], s52 offen lds
    s_add_u32 m0, s50, 139264
    s_mov_b32 s52, 172032
    buffer_load_dwordx4 v12, s[12:15], s52 offen lds
    s_add_u32 m0, s50, 140288
    s_mov_b32 s52, 172032
    buffer_load_dwordx4 v13, s[12:15], s52 offen lds
    s_barrier
    s_cmp_lg_u32 s40, 0
    s_cselect_b64 vcc, -1, 0
    s_add_u32 m0, s50, 114688
    s_mov_b32 s52, 344064
    buffer_load_dwordx4 v12, s[12:15], s52 offen lds
    s_add_u32 m0, s50, 115712
    s_mov_b32 s52, 344064
    buffer_load_dwordx4 v13, s[12:15], s52 offen lds
    s_add_u32 m0, s50, 122880
    s_mov_b32 s52, 516096
    buffer_load_dwordx4 v12, s[12:15], s52 offen lds
    s_add_u32 m0, s50, 123904
    s_mov_b32 s52, 516096
    buffer_load_dwordx4 v13, s[12:15], s52 offen lds
    s_mov_b32 s64, 0
L_spin_2:
    ds_read_b32 v4, v216 offset:24
    s_add_u32 s64, s64, 1
    s_waitcnt lgkmcnt(0)
    s_cmp_gt_u32 s64, 0x200000
    v_readfirstlane_b32 s44, v4
    s_cbranch_scc1 L_spind_3
    s_cmp_lg_u32 s44, 4
    s_cbranch_scc1 L_spin_2
L_spind_3:
    s_add_u32 m0, s50, 149504
    s_mov_b32 s52, 688128
    buffer_load_dwordx4 v12, s[12:15], s52 offen lds
    s_add_u32 m0, s50, 150528
    s_mov_b32 s52, 688128
    buffer_load_dwordx4 v13, s[12:15], s52 offen lds
    s_waitcnt vmcnt(6)
    s_mov_b64 exec, 1
    ds_add_u32 v216, v250 offset:32
    s_mov_b64 exec, -1
    s_mov_b32 s64, 0
L_spin_4:
    ds_read_b32 v4, v216 offset:32
    s_add_u32 s64, s64, 1
    s_waitcnt lgkmcnt(0)
    s_cmp_gt_u32 s64, 0x200000
    v_readfirstlane_b32 s44, v4
    s_cbranch_scc1 L_spind_5
    s_cmp_lg_u32 s44, 4
    s_cbranch_scc1 L_spin_4
L_spind_5:
    ds_read_b128 v[24:27], v16 offset:0
    ds_read_b64_tr_b16 v[44:45], v251 offset:16384
    ds_read_b64_tr_b16 v[46:47], v251 offset:16896
    ds_read_b128 v[28:31], v16 offset:2048
    ds_read_b128 v[32:35], v16 offset:4096
    ds_read_b128 v[36:39], v16 offset:6144
    ds_read_b64_tr_b16 v[48:49], v252 offset:16384
    ds_read_b64_tr_b16 v[50:51], v252 offset:16896
    ds_read_b128 v[40:43], v15 offset:0
    s_waitcnt lgkmcnt(6)
    v_mfma_f32_16x16x32_bf16 v[112:115], v[44:47], v[24:27], v[232:235]
    ds_read_b128 v[52:55], v17 offset:0
    ds_read_b64_tr_b16 v[72:73], v251 offset:20480
    s_waitcnt lgkmcnt(7)
    v_mfma_f32_16x16x32_bf16 v[120:123], v[44:47], v[28:31], v[232:235]
    ds_read_b64_tr_b16 v[74:75], v251 offset:20992
    s_waitcnt lgkmcnt(7)
    v_mfma_f32_16x16x32_bf16 v[128:131], v[44:47], v[32:35], v[232:235]
    ds_read_b128 v[56:59], v17 offset:2048
    s_waitcnt lgkmcnt(7)
    v_mfma_f32_16x16x32_bf16 v[136:139], v[44:47], v[36:39], v[232:235]
    ds_read_b128 v[60:63], v17 offset:4096
    ds_read_b128 v[64:67], v17 offset:6144
    s_waitcnt lgkmcnt(7)
    v_mfma_f32_16x16x32_bf16 v[116:119], v[48:51], v[24:27], v[232:235]
    ds_read_b64_tr_b16 v[76:77], v252 offset:20480
    v_mfma_f32_16x16x32_bf16 v[124:127], v[48:51], v[28:31], v[232:235]
    ds_read_b64_tr_b16 v[78:79], v252 offset:20992
    v_mfma_f32_16x16x32_bf16 v[132:135], v[48:51], v[32:35], v[232:235]
    ds_read_b128 v[68:71], v15 offset:64
    v_mfma_f32_16x16x32_bf16 v[140:143], v[48:51], v[36:39], v[232:235]
    s_waitcnt lgkmcnt(9)
    s_cbranch_vccnz L_s_7
    s_cmp_eq_u32 s38, 1
    s_cbranch_scc1 L_s_6
    v_mfma_f32_16x16x32_bf16 v[144:147], v[40:43], v[24:27], 0
    v_mfma_f32_16x16x32_bf16 v[148:151], v[40:43], v[28:31], 0
    s_branch L_s_7
L_s_6:
    v_mfma_f32_16x16x32_bf16 v[144:147], v[40:43], v[32:35], 0
    v_mfma_f32_16x16x32_bf16 v[148:151], v[40:43], v[36:39], 0
L_s_7:
    s_waitcnt lgkmcnt(6)
    v_mfma_f32_16x16x32_bf16 v[112:115], v[72:75], v[52:55], v[112:115]
    ds_read_b128 v[24:27], v16 offset:16384
    ds_read_b64_tr_b16 v[44:45], v251 offset:24576
    s_waitcnt lgkmcnt(7)
    v_mfma_f32_16x16x32_bf16 v[120:123], v[72:75], v[56:59], v[120:123]
    ds_read_b64_tr_b16 v[46:47], v251 offset:25088
    s_waitcnt lgkmcnt(7)
    v_mfma_f32_16x16x32_bf16 v[128:131], v[72:75], v[60:63], v[128:131]
    ds_read_b128 v[28:31], v16 offset:18432
    s_waitcnt lgkmcnt(7)
    v_mfma_f32_16x16x32_bf16 v[136:139], v[72:75], v[64:67], v[136:139]
    ds_read_b128 v[32:35], v16 offset:20480
    ds_read_b128 v[36:39], v16 offset:22528
    s_waitcnt lgkmcnt(7)
    v_mfma_f32_16x16x32_bf16 v[116:119], v[76:79], v[52:55], v[116:119]
    ds_read_b64_tr_b16 v[48:49], v252 offset:24576
    v_mfma_f32_16x16x32_bf16 v[124:127], v[76:79], v[56:59], v[124:127]
    ds_read_b64_tr_b16 v[50:51], v252 offset:25088
    v_mfma_f32_16x16x32_bf16 v[132:135], v[76:79], v[60:63], v[132:135]
    ds_read_b128 v[40:43], v15 offset:128
    v_mfma_f32_16x16x32_bf16 v[140:143], v[76:79], v[64:67], v[140:143]
    s_waitcnt lgkmcnt(9)
    s_cbranch_vccnz L_s_9
    s_cmp_eq_u32 s38, 1
    s_cbranch_scc1 L_s_8
    v_mfma_f32_16x16x32_bf16 v[144:147], v[68:71], v[52:55], v[144:147]
    v_mfma_f32_16x16x32_bf16 v[148:151], v[68:71], v[56:59], v[148:151]
    s_branch L_s_9
L_s_8:
    v_mfma_f32_16x16x32_bf16 v[144:147], v[68:71], v[60:63], v[144:147]
    v_mfma_f32_16x16x32_bf16 v[148:151], v[68:71], v[64:67], v[148:151]
L_s_9:
    s_waitcnt lgkmcnt(6)
    v_mfma_f32_16x16x32_bf16 v[112:115], v[44:47], v[24:27], v[112:115]
    ds_read_b128 v[52:55], v17 offset:16384
    ds_read_b64_tr_b16 v[72:73], v251 offset:28672
    s_waitcnt lgkmcnt(7)
    v_mfma_f32_16x16x32_bf16 v[120:123], v[44:47], v[28:31], v[120:123]
    ds_read_b64_tr_b16 v[74:75], v251 offset:29184
    s_waitcnt lgkmcnt(7)
    v_mfma_f32_16x16x32_bf16 v[128:131], v[44:47], v[32:35], v[128:131]
    ds_read_b128 v[56:59], v17 offset:18432
    s_waitcnt lgkmcnt(7)
    v_mfma_f32_16x16x32_bf16 v[136:139], v[44:47], v[36:39], v[136:139]
    ds_read_b128 v[60:63], v17 offset:20480
    ds_read_b128 v[64:67], v17 offset:22528
    s_waitcnt lgkmcnt(7)
    v_mfma_f32_16x16x32_bf16 v[116:119], v[48:51], v[24:27], v[116:119]
    ds_read_b64_tr_b16 v[76:77], v252 offset:28672
    v_mfma_f32_16x16x32_bf16 v[124:127], v[48:51], v[28:31], v[124:127]
    ds_read_b64_tr_b16 v[78:79], v252 offset:29184
    v_mfma_f32_16x16x32_bf16 v[132:135], v[48:51], v[32:35], v[132:135]
    ds_read_b128 v[68:71], v15 offset:192
    v_mfma_f32_16x16x32_bf16 v[140:143], v[48:51], v[36:39], v[140:143]
    s_waitcnt lgkmcnt(9)
    s_cbranch_vccnz L_s_11
    s_cmp_eq_u32 s38, 1
    s_cbranch_scc1 L_s_10
    v_mfma_f32_16x16x32_bf16 v[144:147], v[40:43], v[24:27], v[144:147]
    v_mfma_f32_16x16x32_bf16 v[148:151], v[40:43], v[28:31], v[148:151]
    s_branch L_s_11
L_s_10:
    v_mfma_f32_16x16x32_bf16 v[144:147], v[40:43], v[32:35], v[144:147]
    v_mfma_f32_16x16x32_bf16 v[148:151], v[40:43], v[36:39], v[148:151]
L_s_11:
    s_waitcnt lgkmcnt(0)
    s_mov_b64 exec, 1
    ds_add_u32 v216, v250 offset:48
    s_mov_b64 exec, -1
    v_mfma_f32_16x16x32_bf16 v[112:115], v[72:75], v[52:55], v[112:115]
    v_mfma_f32_16x16x32_bf16 v[120:123], v[72:75], v[56:59], v[120:123]
    v_mfma_f32_16x16x32_bf16 v[128:131], v[72:75], v[60:63], v[128:131]
    v_mfma_f32_16x16x32_bf16 v[136:139], v[72:75], v[64:67], v[136:139]
    v_mfma_f32_16x16x32_bf16 v[116:119], v[76:79], v[52:55], v[116:119]
    v_mfma_f32_16x16x32_bf16 v[124:127], v[76:79], v[56:59], v[124:127]
    v_mfma_f32_16x16x32_bf16 v[132:135], v[76:79], v[60:63], v[132:135]
    v_mfma_f32_16x16x32_bf16 v[140:143], v[76:79], v[64:67], v[140:143]
    s_cbranch_vccnz L_s_13
    s_cmp_eq_u32 s38, 1
    s_cbranch_scc1 L_s_12
    v_mfma_f32_16x16x32_bf16 v[144:147], v[68:71], v[52:55], v[144:147]
    v_mfma_f32_16x16x32_bf16 v[148:151], v[68:71], v[56:59], v[148:151]
    s_branch L_s_13
L_s_12:
    v_mfma_f32_16x16x32_bf16 v[144:147], v[68:71], v[60:63], v[144:147]
    v_mfma_f32_16x16x32_bf16 v[148:151], v[68:71], v[64:67], v[148:151]
L_s_13:
    s_mov_b32 s64, 0
L_spin_14:
    ds_read_b32 v4, v216 offset:48
    s_add_u32 s64, s64, 1
    s_waitcnt lgkmcnt(0)
    s_cmp_gt_u32 s64, 0x200000
    v_readfirstlane_b32 s44, v4
    s_cbranch_scc1 L_spind_15
    s_cmp_lg_u32 s44, 4
    s_cbranch_scc1 L_spin_14
L_spind_15:
    s_add_u32 m0, s50, 131072
    s_mov_b32 s52, 860160
    buffer_load_dwordx4 v12, s[12:15], s52 offen lds
    s_add_u32 m0, s50, 132096
    s_mov_b32 s52, 860160
    buffer_load_dwordx4 v13, s[12:15], s52 offen lds
    s_add_u32 m0, s50, 139264
    s_mov_b32 s52, 1032192
    buffer_load_dwordx4 v12, s[12:15], s52 offen lds
    s_add_u32 m0, s50, 140288
    s_mov_b32 s52, 1032192
    buffer_load_dwordx4 v13, s[12:15], s52 offen lds
    s_waitcnt vmcnt(4)
    s_mov_b64 exec, 1
    ds_add_u32 v216, v250 offset:36
    s_mov_b64 exec, -1
    s_mov_b32 s64, 0
L_spin_16:
    ds_read_b32 v4, v216 offset:36
    s_add_u32 s64, s64, 1
    s_waitcnt lgkmcnt(0)
    s_cmp_gt_u32 s64, 0x200000
    v_readfirstlane_b32 s44, v4
    s_cbranch_scc1 L_spind_17
    s_cmp_lg_u32 s44, 4
    s_cbranch_scc1 L_spin_16
L_spind_17:
    ds_read_b128 v[24:27], v16 offset:32768
    ds_read_b64_tr_b16 v[44:45], v251 offset:0
    ds_read_b64_tr_b16 v[46:47], v251 offset:512
    ds_read_b128 v[28:31], v16 offset:34816
    ds_read_b128 v[32:35], v16 offset:36864
    ds_read_b128 v[36:39], v16 offset:38912
    ds_read_b64_tr_b16 v[48:49], v252 offset:0
    ds_read_b64_tr_b16 v[50:51], v252 offset:512
    ds_read_b128 v[40:43], v15 offset:256
    s_waitcnt lgkmcnt(6)
    v_mfma_f32_16x16x32_bf16 v[112:115], v[44:47], v[24:27], v[112:115]
    ds_read_b128 v[52:55], v17 offset:32768
    ds_read_b64_tr_b16 v[72:73], v251 offset:4096
    s_waitcnt lgkmcnt(7)
    v_mfma_f32_16x16x32_bf16 v[120:123], v[44:47], v[28:31], v[120:123]
    ds_read_b64_tr_b16 v[74:75], v251 offset:4608
    s_waitcnt lgkmcnt(7)
    v_mfma_f32_16x16x32_bf16 v[128:131], v[44:47], v[32:35], v[128:131]
    ds_read_b128 v[56:59], v17 offset:34816
    s_waitcnt lgkmcnt(7)
    v_mfma_f32_16x16x32_bf16 v[136:139], v[44:47], v[36:39], v[136:139]
    ds_read_b128 v[60:63], v17 offset:36864
    ds_read_b128 v[64:67], v17 offset:38912
    s_waitcnt lgkmcnt(7)
    v_mfma_f32_16x16x32_bf16 v[116:119], v[48:51], v[24:27], v[116:119]
    ds_read_b64_tr_b16 v[76:77], v252 offset:4096
    v_mfma_f32_16x16x32_bf16 v[124:127], v[48:51], v[28:31], v[124:127]
    ds_read_b64_tr_b16 v[78:79], v252 offset:4608
    v_mfma_f32_16x16x32_bf16 v[132:135], v[48:51], v[32:35], v[132:135]
    ds_read_b128 v[68:71], v15 offset:320
    v_mfma_f32_16x16x32_bf16 v[140:143], v[48:51], v[36:39], v[140:143]
    s_waitcnt lgkmcnt(9)
    s_cbranch_vccnz L_s_19
    s_cmp_eq_u32 s38, 1
    s_cbranch_scc1 L_s_18
    v_mfma_f32_16x16x32_bf16 v[144:147], v[40:43], v[24:27], v[144:147]
    v_mfma_f32_16x16x32_bf16 v[148:151], v[40:43], v[28:31], v[148:151]
    s_branch L_s_19
L_s_18:
    v_mfma_f32_16x16x32_bf16 v[144:147], v[40:43], v[32:35], v[144:147]
    v_mfma_f32_16x16x32_bf16 v[148:151], v[40:43], v[36:39], v[148:151]
L_s_19:
    s_waitcnt lgkmcnt(6)
    v_mfma_f32_16x16x32_bf16 v[112:115], v[72:75], v[52:55], v[112:115]
    ds_read_b128 v[24:27], v16 offset:49152
    ds_read_b64_tr_b16 v[44:45], v251 offset:8192
    s_waitcnt lgkmcnt(7)
    v_mfma_f32_16x16x32_bf16 v[120:123], v[72:75], v[56:59], v[120:123]
    ds_read_b64_tr_b16 v[46:47], v251 offset:8704
    s_waitcnt lgkmcnt(7)
    v_mfma_f32_16x16x32_bf16 v[128:131], v[72:75], v[60:63], v[128:131]
    ds_read_b128 v[28:31], v16 offset:51200
    s_waitcnt lgkmcnt(7)
    v_mfma_f32_16x16x32_bf16 v[136:139], v[72:75], v[64:67], v[136:139]
    ds_read_b128 v[32:35], v16 offset:53248
    ds_read_b128 v[36:39], v16 offset:55296
    s_waitcnt lgkmcnt(7)
    v_mfma_f32_16x16x32_bf16 v[116:119], v[76:79], v[52:55], v[116:119]
    ds_read_b64_tr_b16 v[48:49], v252 offset:8192
    v_mfma_f32_16x16x32_bf16 v[124:127], v[76:79], v[56:59], v[124:127]
    ds_read_b64_tr_b16 v[50:51], v252 offset:8704
    v_mfma_f32_16x16x32_bf16 v[132:135], v[76:79], v[60:63], v[132:135]
    ds_read_b128 v[40:43], v15 offset:384
    v_mfma_f32_16x16x32_bf16 v[140:143], v[76:79], v[64:67], v[140:143]
    s_waitcnt lgkmcnt(9)
    s_cbranch_vccnz L_s_21
    s_cmp_eq_u32 s38, 1
    s_cbranch_scc1 L_s_20
    v_mfma_f32_16x16x32_bf16 v[144:147], v[68:71], v[52:55], v[144:147]
    v_mfma_f32_16x16x32_bf16 v[148:151], v[68:71], v[56:59], v[148:151]
    s_branch L_s_21
L_s_20:
    v_mfma_f32_16x16x32_bf16 v[144:147], v[68:71], v[60:63], v[144:147]
    v_mfma_f32_16x16x32_bf16 v[148:151], v[68:71], v[64:67], v[148:151]
L_s_21:
    s_waitcnt lgkmcnt(6)
    v_mfma_f32_16x16x32_bf16 v[112:115], v[44:47], v[24:27], v[112:115]
    ds_read_b128 v[52:55], v17 offset:49152
    ds_read_b64_tr_b16 v[72:73], v251 offset:12288
    s_waitcnt lgkmcnt(7)
    v_mfma_f32_16x16x32_bf16 v[120:123], v[44:47], v[28:31], v[120:123]
    ds_read_b64_tr_b16 v[74:75], v251 offset:12800
    s_waitcnt lgkmcnt(7)
    v_mfma_f32_16x16x32_bf16 v[128:131], v[44:47], v[32:35], v[128:131]
    ds_read_b128 v[56:59], v17 offset:51200
    s_waitcnt lgkmcnt(7)
    v_mfma_f32_16x16x32_bf16 v[136:139], v[44:47], v[36:39], v[136:139]
    ds_read_b128 v[60:63], v17 offset:53248
    ds_read_b128 v[64:67], v17 offset:55296
    s_waitcnt lgkmcnt(7)
    v_mfma_f32_16x16x32_bf16 v[116:119], v[48:51], v[24:27], v[116:119]
    ds_read_b64_tr_b16 v[76:77], v252 offset:12288
    v_mfma_f32_16x16x32_bf16 v[124:127], v[48:51], v[28:31], v[124:127]
    ds_read_b64_tr_b16 v[78:79], v252 offset:12800
    v_mfma_f32_16x16x32_bf16 v[132:135], v[48:51], v[32:35], v[132:135]
    ds_read_b128 v[68:71], v15 offset:448
    v_mfma_f32_16x16x32_bf16 v[140:143], v[48:51], v[36:39], v[140:143]
    s_waitcnt lgkmcnt(9)
    s_cbranch_vccnz L_s_23
    s_cmp_eq_u32 s38, 1
    s_cbranch_scc1 L_s_22
    v_mfma_f32_16x16x32_bf16 v[144:147], v[40:43], v[24:27], v[144:147]
    v_mfma_f32_16x16x32_bf16 v[148:151], v[40:43], v[28:31], v[148:151]
    s_branch L_s_23
L_s_22:
    v_mfma_f32_16x16x32_bf16 v[144:147], v[40:43], v[32:35], v[144:147]
    v_mfma_f32_16x16x32_bf16 v[148:151], v[40:43], v[36:39], v[148:151]
L_s_23:
    s_waitcnt lgkmcnt(6)
    v_mfma_f32_16x16x32_bf16 v[112:115], v[72:75], v[52:55], v[112:115]
    ds_read_b128 v[24:27], v18 offset:0
    ds_read_b64_tr_b16 v[44:45], v251 offset:34816
    s_waitcnt lgkmcnt(7)
    v_mfma_f32_16x16x32_bf16 v[120:123], v[72:75], v[56:59], v[120:123]
    ds_read_b64_tr_b16 v[46:47], v251 offset:35328
    s_waitcnt lgkmcnt(7)
    v_mfma_f32_16x16x32_bf16 v[128:131], v[72:75], v[60:63], v[128:131]
    ds_read_b128 v[28:31], v18 offset:2048
    s_waitcnt lgkmcnt(7)
    v_mfma_f32_16x16x32_bf16 v[136:139], v[72:75], v[64:67], v[136:139]
    ds_read_b128 v[32:35], v18 offset:4096
    ds_read_b128 v[36:39], v18 offset:6144
    s_waitcnt lgkmcnt(7)
    v_mfma_f32_16x16x32_bf16 v[116:119], v[76:79], v[52:55], v[116:119]
    ds_read_b64_tr_b16 v[48:49], v252 offset:34816
    v_mfma_f32_16x16x32_bf16 v[124:127], v[76:79], v[56:59], v[124:127]
    ds_read_b64_tr_b16 v[50:51], v252 offset:35328
    v_mfma_f32_16x16x32_bf16 v[132:135], v[76:79], v[60:63], v[132:135]
    ds_read_b128 v[40:43], v15 offset:512
    v_mfma_f32_16x16x32_bf16 v[140:143], v[76:79], v[64:67], v[140:143]
    s_waitcnt lgkmcnt(9)
    s_cbranch_vccnz L_s_25
    s_cmp_eq_u32 s38, 1
    s_cbranch_scc1 L_s_24
    v_mfma_f32_16x16x32_bf16 v[144:147], v[68:71], v[52:55], v[144:147]
    v_mfma_f32_16x16x32_bf16 v[148:151], v[68:71], v[56:59], v[148:151]
    s_branch L_s_25
L_s_24:
    v_mfma_f32_16x16x32_bf16 v[144:147], v[68:71], v[60:63], v[144:147]
    v_mfma_f32_16x16x32_bf16 v[148:151], v[68:71], v[64:67], v[148:151]
L_s_25:
    s_waitcnt lgkmcnt(6)
    v_mfma_f32_16x16x32_bf16 v[112:115], v[44:47], v[24:27], v[112:115]
    ds_read_b128 v[52:55], v19 offset:0
    ds_read_b64_tr_b16 v[72:73], v251 offset:38912
    s_waitcnt lgkmcnt(7)
    v_mfma_f32_16x16x32_bf16 v[120:123], v[44:47], v[28:31], v[120:123]
    ds_read_b64_tr_b16 v[74:75], v251 offset:39424
    s_waitcnt lgkmcnt(7)
    v_mfma_f32_16x16x32_bf16 v[128:131], v[44:47], v[32:35], v[128:131]
    ds_read_b128 v[56:59], v19 offset:2048
    s_waitcnt lgkmcnt(7)
    v_mfma_f32_16x16x32_bf16 v[136:139], v[44:47], v[36:39], v[136:139]
    ds_read_b128 v[60:63], v19 offset:4096
    ds_read_b128 v[64:67], v19 offset:6144
    s_waitcnt lgkmcnt(7)
    v_mfma_f32_16x16x32_bf16 v[116:119], v[48:51], v[24:27], v[116:119]
    ds_read_b64_tr_b16 v[76:77], v252 offset:38912
    v_mfma_f32_16x16x32_bf16 v[124:127], v[48:51], v[28:31], v[124:127]
    ds_read_b64_tr_b16 v[78:79], v252 offset:39424
    v_mfma_f32_16x16x32_bf16 v[132:135], v[48:51], v[32:35], v[132:135]
    ds_read_b128 v[68:71], v15 offset:576
    v_mfma_f32_16x16x32_bf16 v[140:143], v[48:51], v[36:39], v[140:143]
    s_waitcnt lgkmcnt(9)
    s_cbranch_vccnz L_s_27
    s_cmp_eq_u32 s38, 1
    s_cbranch_scc1 L_s_26
    v_mfma_f32_16x16x32_bf16 v[144:147], v[40:43], v[24:27], v[144:147]
    v_mfma_f32_16x16x32_bf16 v[148:151], v[40:43], v[28:31], v[148:151]
    s_branch L_s_27
L_s_26:
    v_mfma_f32_16x16x32_bf16 v[144:147], v[40:43], v[32:35], v[144:147]
    v_mfma_f32_16x16x32_bf16 v[148:151], v[40:43], v[36:39], v[148:151]
L_s_27:
    s_waitcnt lgkmcnt(6)
    v_mfma_f32_16x16x32_bf16 v[112:115], v[72:75], v[52:55], v[112:115]
    s_waitcnt lgkmcnt(5)
    v_mfma_f32_16x16x32_bf16 v[120:123], v[72:75], v[56:59], v[120:123]
    s_waitcnt lgkmcnt(4)
    v_mfma_f32_16x16x32_bf16 v[128:131], v[72:75], v[60:63], v[128:131]
    s_waitcnt lgkmcnt(3)
    v_mfma_f32_16x16x32_bf16 v[136:139], v[72:75], v[64:67], v[136:139]
    s_waitcnt lgkmcnt(1)
    v_mfma_f32_16x16x32_bf16 v[116:119], v[76:79], v[52:55], v[116:119]
    v_mfma_f32_16x16x32_bf16 v[124:127], v[76:79], v[56:59], v[124:127]
    v_mfma_f32_16x16x32_bf16 v[132:135], v[76:79], v[60:63], v[132:135]
    v_mfma_f32_16x16x32_bf16 v[140:143], v[76:79], v[64:67], v[140:143]
    s_waitcnt lgkmcnt(0)
    s_cbranch_vccnz L_s_29
    s_cmp_eq_u32 s38, 1
    s_cbranch_scc1 L_s_28
    v_mfma_f32_16x16x32_bf16 v[144:147], v[68:71], v[52:55], v[144:147]
    v_mfma_f32_16x16x32_bf16 v[148:151], v[68:71], v[56:59], v[148:151]
    s_branch L_s_29
L_s_28:
    v_mfma_f32_16x16x32_bf16 v[144:147], v[68:71], v[60:63], v[144:147]
    v_mfma_f32_16x16x32_bf16 v[148:151], v[68:71], v[64:67], v[148:151]
L_s_29:
    s_waitcnt vmcnt(0)
    s_mov_b64 exec, 1
    ds_add_u32 v216, v250 offset:40
    s_mov_b64 exec, -1
    s_mov_b32 s64, 0
L_spin_30:
    ds_read_b32 v4, v216 offset:40
    s_add_u32 s64, s64, 1
    s_waitcnt lgkmcnt(0)
    s_cmp_gt_u32 s64, 0x200000
    v_readfirstlane_b32 s44, v4
    s_cbranch_scc1 L_spind_31
    s_cmp_lg_u32 s44, 4
    s_cbranch_scc1 L_spin_30
L_spind_31:
    ds_read_b128 v[24:27], v18 offset:16384
    ds_read_b64_tr_b16 v[44:45], v251 offset:16384
    ds_read_b64_tr_b16 v[46:47], v251 offset:16896
    ds_read_b128 v[28:31], v18 offset:18432
    ds_read_b128 v[32:35], v18 offset:20480
    ds_read_b128 v[36:39], v18 offset:22528
    ds_read_b64_tr_b16 v[48:49], v252 offset:16384
    ds_read_b64_tr_b16 v[50:51], v252 offset:16896
    ds_read_b128 v[40:43], v15 offset:640
    s_waitcnt lgkmcnt(6)
    v_mfma_f32_16x16x32_bf16 v[112:115], v[44:47], v[24:27], v[112:115]
    ds_read_b128 v[52:55], v19 offset:16384
    ds_read_b64_tr_b16 v[72:73], v251 offset:20480
    s_waitcnt lgkmcnt(7)
    v_mfma_f32_16x16x32_bf16 v[120:123], v[44:47], v[28:31], v[120:123]
    ds_read_b64_tr_b16 v[74:75], v251 offset:20992
    s_waitcnt lgkmcnt(7)
    v_mfma_f32_16x16x32_bf16 v[128:131], v[44:47], v[32:35], v[128:131]
    ds_read_b128 v[56:59], v19 offset:18432
    s_waitcnt lgkmcnt(7)
    v_mfma_f32_16x16x32_bf16 v[136:139], v[44:47], v[36:39], v[136:139]
    ds_read_b128 v[60:63], v19 offset:20480
    ds_read_b128 v[64:67], v19 offset:22528
    s_waitcnt lgkmcnt(7)
    v_mfma_f32_16x16x32_bf16 v[116:119], v[48:51], v[24:27], v[116:119]
    ds_read_b64_tr_b16 v[76:77], v252 offset:20480
    v_mfma_f32_16x16x32_bf16 v[124:127], v[48:51], v[28:31], v[124:127]
    ds_read_b64_tr_b16 v[78:79], v252 offset:20992
    v_mfma_f32_16x16x32_bf16 v[132:135], v[48:51], v[32:35], v[132:135]
    ds_read_b128 v[68:71], v15 offset:704
    v_mfma_f32_16x16x32_bf16 v[140:143], v[48:51], v[36:39], v[140:143]
    s_waitcnt lgkmcnt(9)
    s_cbranch_vccnz L_s_33
    s_cmp_eq_u32 s38, 1
    s_cbranch_scc1 L_s_32
    v_mfma_f32_16x16x32_bf16 v[144:147], v[40:43], v[24:27], v[144:147]
    v_mfma_f32_16x16x32_bf16 v[148:151], v[40:43], v[28:31], v[148:151]
    s_branch L_s_33
L_s_32:
    v_mfma_f32_16x16x32_bf16 v[144:147], v[40:43], v[32:35], v[144:147]
    v_mfma_f32_16x16x32_bf16 v[148:151], v[40:43], v[36:39], v[148:151]
L_s_33:
    s_waitcnt lgkmcnt(6)
    v_mfma_f32_16x16x32_bf16 v[112:115], v[72:75], v[52:55], v[112:115]
    ds_read_b128 v[24:27], v18 offset:32768
    ds_read_b64_tr_b16 v[44:45], v251 offset:24576
    s_waitcnt lgkmcnt(7)
    v_mfma_f32_16x16x32_bf16 v[120:123], v[72:75], v[56:59], v[120:123]
    ds_read_b64_tr_b16 v[46:47], v251 offset:25088
    s_waitcnt lgkmcnt(7)
    v_mfma_f32_16x16x32_bf16 v[128:131], v[72:75], v[60:63], v[128:131]
    ds_read_b128 v[28:31], v18 offset:34816
    s_waitcnt lgkmcnt(7)
    v_mfma_f32_16x16x32_bf16 v[136:139], v[72:75], v[64:67], v[136:139]
    ds_read_b128 v[32:35], v18 offset:36864
    ds_read_b128 v[36:39], v18 offset:38912
    s_waitcnt lgkmcnt(7)
    v_mfma_f32_16x16x32_bf16 v[116:119], v[76:79], v[52:55], v[116:119]
    ds_read_b64_tr_b16 v[48:49], v252 offset:24576
    v_mfma_f32_16x16x32_bf16 v[124:127], v[76:79], v[56:59], v[124:127]
    ds_read_b64_tr_b16 v[50:51], v252 offset:25088
    v_mfma_f32_16x16x32_bf16 v[132:135], v[76:79], v[60:63], v[132:135]
    ds_read_b128 v[40:43], v15 offset:768
    v_mfma_f32_16x16x32_bf16 v[140:143], v[76:79], v[64:67], v[140:143]
    s_waitcnt lgkmcnt(9)
    s_cbranch_vccnz L_s_35
    s_cmp_eq_u32 s38, 1
    s_cbranch_scc1 L_s_34
    v_mfma_f32_16x16x32_bf16 v[144:147], v[68:71], v[52:55], v[144:147]
    v_mfma_f32_16x16x32_bf16 v[148:151], v[68:71], v[56:59], v[148:151]
    s_branch L_s_35
L_s_34:
    v_mfma_f32_16x16x32_bf16 v[144:147], v[68:71], v[60:63], v[144:147]
    v_mfma_f32_16x16x32_bf16 v[148:151], v[68:71], v[64:67], v[148:151]
L_s_35:
    s_waitcnt lgkmcnt(6)
    v_mfma_f32_16x16x32_bf16 v[112:115], v[44:47], v[24:27], v[112:115]
    ds_read_b128 v[52:55], v19 offset:32768
    ds_read_b64_tr_b16 v[72:73], v251 offset:28672
    s_waitcnt lgkmcnt(7)
    v_mfma_f32_16x16x32_bf16 v[120:123], v[44:47], v[28:31], v[120:123]
    ds_read_b64_tr_b16 v[74:75], v251 offset:29184
    s_waitcnt lgkmcnt(7)
    v_mfma_f32_16x16x32_bf16 v[128:131], v[44:47], v[32:35], v[128:131]
    ds_read_b128 v[56:59], v19 offset:34816
    s_waitcnt lgkmcnt(7)
    v_mfma_f32_16x16x32_bf16 v[136:139], v[44:47], v[36:39], v[136:139]
    ds_read_b128 v[60:63], v19 offset:36864
    ds_read_b128 v[64:67], v19 offset:38912
    s_waitcnt lgkmcnt(7)
    v_mfma_f32_16x16x32_bf16 v[116:119], v[48:51], v[24:27], v[116:119]
    ds_read_b64_tr_b16 v[76:77], v252 offset:28672
    v_mfma_f32_16x16x32_bf16 v[124:127], v[48:51], v[28:31], v[124:127]
    ds_read_b64_tr_b16 v[78:79], v252 offset:29184
    v_mfma_f32_16x16x32_bf16 v[132:135], v[48:51], v[32:35], v[132:135]
    ds_read_b128 v[68:71], v15 offset:832
    v_mfma_f32_16x16x32_bf16 v[140:143], v[48:51], v[36:39], v[140:143]
    s_waitcnt lgkmcnt(9)
    s_cbranch_vccnz L_s_37
    s_cmp_eq_u32 s38, 1
    s_cbranch_scc1 L_s_36
    v_mfma_f32_16x16x32_bf16 v[144:147], v[40:43], v[24:27], v[144:147]
    v_mfma_f32_16x16x32_bf16 v[148:151], v[40:43], v[28:31], v[148:151]
    s_branch L_s_37
L_s_36:
    v_mfma_f32_16x16x32_bf16 v[144:147], v[40:43], v[32:35], v[144:147]
    v_mfma_f32_16x16x32_bf16 v[148:151], v[40:43], v[36:39], v[148:151]
L_s_37:
    s_waitcnt lgkmcnt(6)
    v_mfma_f32_16x16x32_bf16 v[112:115], v[72:75], v[52:55], v[112:115]
    s_waitcnt lgkmcnt(5)
    v_mfma_f32_16x16x32_bf16 v[120:123], v[72:75], v[56:59], v[120:123]
    s_waitcnt lgkmcnt(4)
    v_mfma_f32_16x16x32_bf16 v[128:131], v[72:75], v[60:63], v[128:131]
    s_waitcnt lgkmcnt(3)
    v_mfma_f32_16x16x32_bf16 v[136:139], v[72:75], v[64:67], v[136:139]
    s_waitcnt lgkmcnt(1)
    v_mfma_f32_16x16x32_bf16 v[116:119], v[76:79], v[52:55], v[116:119]
    v_mfma_f32_16x16x32_bf16 v[124:127], v[76:79], v[56:59], v[124:127]
    v_mfma_f32_16x16x32_bf16 v[132:135], v[76:79], v[60:63], v[132:135]
    v_mfma_f32_16x16x32_bf16 v[140:143], v[76:79], v[64:67], v[140:143]
    s_waitcnt lgkmcnt(0)
    s_cbranch_vccnz L_s_39
    s_cmp_eq_u32 s38, 1
    s_cbranch_scc1 L_s_38
    v_mfma_f32_16x16x32_bf16 v[144:147], v[68:71], v[52:55], v[144:147]
    v_mfma_f32_16x16x32_bf16 v[148:151], v[68:71], v[56:59], v[148:151]
    s_branch L_s_39
L_s_38:
    v_mfma_f32_16x16x32_bf16 v[144:147], v[68:71], v[60:63], v[144:147]
    v_mfma_f32_16x16x32_bf16 v[148:151], v[68:71], v[64:67], v[148:151]
L_s_39:
    s_nop 4
    v_pk_mul_f32 v[24:25], v[112:113], s[68:69]
    v_pk_mul_f32 v[26:27], v[114:115], s[68:69]
    v_pk_mul_f32 v[28:29], v[116:117], s[68:69]
    v_pk_mul_f32 v[30:31], v[118:119], s[68:69]
    v_pk_mul_f32 v[32:33], v[120:121], s[68:69]
    v_pk_mul_f32 v[34:35], v[122:123], s[68:69]
    v_pk_mul_f32 v[36:37], v[124:125], s[68:69]
    v_pk_mul_f32 v[38:39], v[126:127], s[68:69]
    v_pk_mul_f32 v[40:41], v[128:129], s[68:69]
    v_pk_mul_f32 v[42:43], v[130:131], s[68:69]
    v_pk_mul_f32 v[44:45], v[132:133], s[68:69]
    v_pk_mul_f32 v[46:47], v[134:135], s[68:69]
    v_pk_mul_f32 v[48:49], v[136:137], s[68:69]
    v_pk_mul_f32 v[50:51], v[138:139], s[68:69]
    v_pk_mul_f32 v[52:53], v[140:141], s[68:69]
    v_pk_mul_f32 v[54:55], v[142:143], s[68:69]
    v_exp_f32 v24, v24 clamp
    v_exp_f32 v25, v25 clamp
    v_exp_f32 v26, v26 clamp
    v_exp_f32 v27, v27 clamp
    v_exp_f32 v28, v28 clamp
    v_exp_f32 v29, v29 clamp
    v_exp_f32 v30, v30 clamp
    v_exp_f32 v31, v31 clamp
    v_exp_f32 v32, v32 clamp
    v_exp_f32 v33, v33 clamp
    v_exp_f32 v34, v34 clamp
    v_exp_f32 v35, v35 clamp
    v_exp_f32 v36, v36 clamp
    v_exp_f32 v37, v37 clamp
    v_exp_f32 v38, v38 clamp
    v_exp_f32 v39, v39 clamp
    v_exp_f32 v40, v40 clamp
    v_exp_f32 v41, v41 clamp
    v_exp_f32 v42, v42 clamp
    v_exp_f32 v43, v43 clamp
    v_exp_f32 v44, v44 clamp
    v_exp_f32 v45, v45 clamp
    v_exp_f32 v46, v46 clamp
    v_exp_f32 v47, v47 clamp
    v_exp_f32 v48, v48 clamp
    v_exp_f32 v49, v49 clamp
    v_exp_f32 v50, v50 clamp
    v_exp_f32 v51, v51 clamp
    v_exp_f32 v52, v52 clamp
    v_exp_f32 v53, v53 clamp
    v_exp_f32 v54, v54 clamp
    v_exp_f32 v55, v55 clamp
    v_max_f32 v112, s70, v112
    v_max_f32 v113, s70, v113
    v_max_f32 v114, s70, v114
    v_max_f32 v115, s70, v115
    v_max_f32 v116, s70, v116
    v_max_f32 v117, s70, v117
    v_max_f32 v118, s70, v118
    v_max_f32 v119, s70, v119
    v_max_f32 v120, s70, v120
    v_max_f32 v121, s70, v121
    v_max_f32 v122, s70, v122
    v_max_f32 v123, s70, v123
    v_max_f32 v124, s70, v124
    v_max_f32 v125, s70, v125
    v_max_f32 v126, s70, v126
    v_max_f32 v127, s70, v127
    v_max_f32 v128, s70, v128
    v_max_f32 v129, s70, v129
    v_max_f32 v130, s70, v130
    v_max_f32 v131, s70, v131
    v_max_f32 v132, s70, v132
    v_max_f32 v133, s70, v133
    v_max_f32 v134, s70, v134
    v_max_f32 v135, s70, v135
    v_max_f32 v136, s70, v136
    v_max_f32 v137, s70, v137
    v_max_f32 v138, s70, v138
    v_max_f32 v139, s70, v139
    v_max_f32 v140, s70, v140
    v_max_f32 v141, s70, v141
    v_max_f32 v142, s70, v142
    v_max_f32 v143, s70, v143
    v_pk_add_f32 v[112:113], v[112:113], v[24:25]
    v_pk_add_f32 v[114:115], v[114:115], v[26:27]
    v_pk_add_f32 v[116:117], v[116:117], v[28:29]
    v_pk_add_f32 v[118:119], v[118:119], v[30:31]
    v_pk_add_f32 v[120:121], v[120:121], v[32:33]
    v_pk_add_f32 v[122:123], v[122:123], v[34:35]
    v_pk_add_f32 v[124:125], v[124:125], v[36:37]
    v_pk_add_f32 v[126:127], v[126:127], v[38:39]
    v_pk_add_f32 v[128:129], v[128:129], v[40:41]
    v_pk_add_f32 v[130:131], v[130:131], v[42:43]
    v_pk_add_f32 v[132:133], v[132:133], v[44:45]
    v_pk_add_f32 v[134:135], v[134:135], v[46:47]
    v_pk_add_f32 v[136:137], v[136:137], v[48:49]
    v_pk_add_f32 v[138:139], v[138:139], v[50:51]
    v_pk_add_f32 v[140:141], v[140:141], v[52:53]
    v_pk_add_f32 v[142:143], v[142:143], v[54:55]
    s_cbranch_vccnz L_M_nogate
    v_mul_f32 v144, s68, v144
    v_mul_f32 v148, s68, v148
    v_exp_f32 v144, -v144
    v_exp_f32 v148, -v148
    s_nop 0
    v_add_f32 v144, 1.0, v144
    v_add_f32 v148, 1.0, v148
    v_rcp_f32 v144, v144
    v_rcp_f32 v148, v148
    s_mov_b64 exec, 0xffff
    buffer_store_dword v144, v244, s[16:19], s86 offen offset:0 sc1
    buffer_store_dword v148, v244, s[16:19], s86 offen offset:64 sc1
    s_mov_b64 exec, -1
L_M_nogate:
    v_cvt_pk_bf16_f32 v56, v112, v113
    v_cvt_pk_bf16_f32 v57, v114, v115
    v_cvt_pk_bf16_f32 v58, v116, v117
    v_cvt_pk_bf16_f32 v59, v118, v119
    v_cndmask_b32 v58, 0, v58, s[54:55]
    v_cndmask_b32 v59, 0, v59, s[54:55]
    v_cvt_pk_bf16_f32 v60, v120, v121
    v_cvt_pk_bf16_f32 v61, v122, v123
    v_cvt_pk_bf16_f32 v62, v124, v125
    v_cvt_pk_bf16_f32 v63, v126, v127
    v_cndmask_b32 v62, 0, v62, s[54:55]
    v_cndmask_b32 v63, 0, v63, s[54:55]
    v_cvt_pk_bf16_f32 v64, v128, v129
    v_cvt_pk_bf16_f32 v65, v130, v131
    v_cvt_pk_bf16_f32 v66, v132, v133
    v_cvt_pk_bf16_f32 v67, v134, v135
    v_cndmask_b32 v66, 0, v66, s[54:55]
    v_cndmask_b32 v67, 0, v67, s[54:55]
    v_cvt_pk_bf16_f32 v68, v136, v137
    v_cvt_pk_bf16_f32 v69, v138, v139
    v_cvt_pk_bf16_f32 v70, v140, v141
    v_cvt_pk_bf16_f32 v71, v142, v143
    v_cndmask_b32 v70, 0, v70, s[54:55]
    v_cndmask_b32 v71, 0, v71, s[54:55]
    v_subrev_u32 v5, 149504, v217
    ds_write_b128 v5, v[56:59] offset:0
    ds_write_b128 v5, v[60:63] offset:1024
    s_waitcnt vmcnt(0) lgkmcnt(0)
    s_mov_b64 exec, 1
    ds_add_u32 v219, v250 offset:0
    s_mov_b64 exec, -1
    s_mov_b32 s64, 0
L_spin_40:
    ds_read_b32 v4, v223 offset:0
    s_add_u32 s64, s64, 1
    s_waitcnt lgkmcnt(0)
    s_cmp_gt_u32 s64, 0x200000
    v_readfirstlane_b32 s44, v4
    s_cbranch_scc1 L_spind_41
    s_cmp_lg_u32 s44, 2
    s_cbranch_scc1 L_spin_40
L_spind_41:
    ds_read_b128 v[32:35], v222 offset:1216
    ds_read_b128 v[24:27], v221
    ds_read_b128 v[28:31], v221 offset:1024
    s_waitcnt lgkmcnt(2)
    v_mfma_f32_16x16x32_bf16 v[120:123], v[32:35], v[64:67], 0
    v_mfma_f32_16x16x32_bf16 v[132:135], v[32:35], v[68:71], 0
    s_waitcnt lgkmcnt(1)
    v_mfma_f32_16x16x32_bf16 v[112:115], v[24:27], v[64:67], 0
    v_mfma_f32_16x16x32_bf16 v[124:127], v[24:27], v[68:71], 0
    s_waitcnt lgkmcnt(0)
    v_mfma_f32_16x16x32_bf16 v[116:119], v[28:31], v[64:67], 0
    v_mfma_f32_16x16x32_bf16 v[128:131], v[28:31], v[68:71], 0
    s_nop 1
    v_add_f32 v120, s70, v120
    v_add_f32 v132, s70, v132
    v_rcp_f32 v120, v120
    v_rcp_f32 v132, v132
    s_add_u32 s44, s76, 16384
    s_nop 0
    v_mul_f32 v112, v112, v120
    v_mul_f32 v113, v113, v120
    v_mul_f32 v114, v114, v120
    v_mul_f32 v115, v115, v120
    v_mul_f32 v116, v116, v120
    v_mul_f32 v117, v117, v120
    v_mul_f32 v118, v118, v120
    v_mul_f32 v119, v119, v120
    v_cvt_pk_bf16_f32 v136, v112, v113
    v_cvt_pk_bf16_f32 v137, v114, v115
    v_cvt_pk_bf16_f32 v138, v116, v117
    v_cvt_pk_bf16_f32 v139, v118, v119
    v_cndmask_b32 v138, 0, v138, s[54:55]
    v_cndmask_b32 v139, 0, v139, s[54:55]
    buffer_store_dwordx4 v[136:139], v236, s[16:19], s76 offen sc1
    v_mul_f32 v124, v124, v132
    v_mul_f32 v125, v125, v132
    v_mul_f32 v126, v126, v132
    v_mul_f32 v127, v127, v132
    v_mul_f32 v128, v128, v132
    v_mul_f32 v129, v129, v132
    v_mul_f32 v130, v130, v132
    v_mul_f32 v131, v131, v132
    v_cvt_pk_bf16_f32 v140, v124, v125
    v_cvt_pk_bf16_f32 v141, v126, v127
    v_cvt_pk_bf16_f32 v142, v128, v129
    v_cvt_pk_bf16_f32 v143, v130, v131
    v_cndmask_b32 v142, 0, v142, s[54:55]
    v_cndmask_b32 v143, 0, v143, s[54:55]
    buffer_store_dwordx4 v[140:143], v236, s[16:19], s44 offen sc1
    s_waitcnt vmcnt(0)
    v_mov_b32 v24, s42
    v_mov_b32 v25, s43
    s_mov_b64 exec, 1
    buffer_store_dwordx2 v[24:25], off, s[16:19], s77 sc1
    s_mov_b64 exec, -1
    s_endpgm
L_compute:
    s_cmp_eq_u32 s41, 0
    s_cbranch_scc1 L_cB
    v_lshrrev_b32 v9, 1, v2
    v_xor_b32 v9, v3, v9
    v_lshlrev_b32 v9, 4, v9
    v_lshl_add_u32 v9, v2, 7, v9
    s_lshl_b32 s45, s5, 13
    v_add_u32 v10, s45, v9
    v_xor_b32 v11, 64, v10
    v_add_u32 v12, 122880, v9
    v_xor_b32 v13, 64, v12
    v_and_b32 v4, 3, v2
    v_lshlrev_b32 v4, 3, v4
    s_mul_i32 s44, s38, 56
    v_add_u32 v4, s44, v4
    v_and_b32 v5, 8, v2
    v_lshlrev_b32 v5, 2, v5
    v_xor_b32 v4, v4, v5
    v_and_b32 v5, 1, v3
    v_lshlrev_b32 v5, 6, v5
    v_xor_b32 v4, v4, v5
    v_lshrrev_b32 v5, 2, v2
    v_lshl_add_u32 v4, v5, 7, v4
    v_mul_u32_u24 v5, 3072, v3
    v_add_u32 v4, v4, v5
    v_add_u32 v14, 49152, v4
    v_add_u32 v16, 49152, v14
    v_and_b32 v4, 3, v2
    v_lshlrev_b32 v4, 3, v4
    s_mul_i32 s44, s38, 56
    s_add_u32 s44, s44, 32
    v_add_u32 v4, s44, v4
    v_and_b32 v5, 8, v2
    v_lshlrev_b32 v5, 2, v5
    v_xor_b32 v4, v4, v5
    v_and_b32 v5, 1, v3
    v_lshlrev_b32 v5, 6, v5
    v_xor_b32 v4, v4, v5
    v_lshrrev_b32 v5, 2, v2
    v_lshl_add_u32 v4, v5, 7, v4
    v_mul_u32_u24 v5, 3072, v3
    v_add_u32 v4, v4, v5
    v_add_u32 v15, 49152, v4
    v_add_u32 v17, 49152, v15
    s_waitcnt lgkmcnt(0)
    s_cmp_lt_u32 s65, 20
    s_cselect_b32 s8, s78, s84
    s_cselect_b32 s9, s79, s85
    s_cselect_b32 s46, 8, 20
    s_mov_b32 s10, 1204224
    s_mov_b32 s47, 172032
    s_cmp_lt_u32 s65, 8
    s_cselect_b32 s8, s76, s8
    s_cselect_b32 s9, s77, s9
    s_cselect_b32 s10, 1835008, s10
    s_mov_b32 s11, 0x00020000
    s_cselect_b32 s47, 128, s47
    s_cselect_b32 s46, 0, s46
    s_cselect_b64 vcc, -1, 0
    s_sub_u32 s46, s65, s46
    s_lshl_b32 s46, s46, 6
    s_lshl_b32 s45, s4, 4
    s_add_u32 s46, s46, s45
    v_lshrrev_b32 v6, 2, v1
    v_add_u32 v6, s46, v6
    s_lshr_b32 s45, s39, 2
    s_lshl_b32 s45, s45, 9
    v_add_u32 v7, s45, v6
    v_mul_u32_u24 v7, 896, v7
    v_mul_u32_u24 v8, 43691, v6
    v_lshrrev_b32 v8, 19, v8
    v_mul_u32_u24 v4, 12, v8
    v_sub_u32 v6, v6, v4
    v_mul_u32_u24 v8, 2688, v8
    v_lshrrev_b32 v4, 2, v6
    v_mul_u32_u24 v4, 896, v4
    v_add_u32 v8, v8, v4
    v_and_b32 v6, 3, v6
    v_lshl_add_u32 v8, v6, 7, v8
    s_mul_i32 s45, s63, 384
    v_add_u32 v8, s45, v8
    v_cndmask_b32 v8, v8, v7, vcc
    v_mov_b32 v18, v8
    s_mov_b32 s12, s47
    s_mul_i32 s13, s12, 1
    buffer_load_dword v23, v18, s[8:11], s13 offen
    s_mul_i32 s13, s12, 2
    buffer_load_dword v23, v18, s[8:11], s13 offen
    s_mov_b32 s16, s94
    s_mov_b32 s17, s95
    s_mov_b32 s18, 8388608
    s_mov_b32 s19, 0x00020000
    s_load_dwordx2 s[42:43], s[94:95], 0
    s_mov_b32 s20, s80
    s_mov_b32 s21, s81
    s_mov_b32 s22, 401408
    s_mov_b32 s23, 0x00020000
    s_mov_b32 s24, s86
    s_mov_b32 s25, s87
    s_mov_b32 s26, 401408
    s_mov_b32 s27, 0x00020000
    s_mov_b32 s28, s90
    s_mov_b32 s29, s91
    s_mov_b32 s30, 1835008
    s_mov_b32 s31, 0x00020000
    s_mov_b32 s32, s88
    s_mov_b32 s33, s89
    s_mov_b32 s34, 896
    s_mov_b32 s35, 0x00020000
    s_mov_b32 s54, -1
    s_mov_b32 s55, 0xffff
    v_lshlrev_b32 v236, 4, v1
    v_lshlrev_b32 v237, 5, v2
    v_lshlrev_b32 v244, 2, v2
    s_lshl_b32 s44, s39, 1
    s_add_u32 s44, s44, 1
    s_sub_u32 s44, s44, s41
    s_lshl_b32 s44, s44, 2
    s_add_u32 s44, s44, s37
    s_lshl_b32 s45, s40, 1
    s_add_u32 s45, s45, s38
    s_lshl_b32 s46, s44, 5
    s_add_u32 s46, s46, s45
    s_lshl_b32 s46, s46, 10
    s_add_u32 s76, s46, 2097152
    s_lshl_b32 s46, s44, 4
    s_add_u32 s46, s46, s45
    s_lshl_b32 s46, s46, 5
    s_add_u32 s77, s46, 65536
    s_lshl_b32 s44, s39, 4
    s_add_u32 s44, s44, s36
    s_lshl_b32 s45, s44, 14
    s_add_u32 s79, s45, 2097152
    s_lshl_b32 s44, s39, 3
    s_lshr_b32 s45, s36, 1
    s_add_u32 s45, s45, s44
    s_lshl_b32 s45, s45, 9
    s_add_u32 s78, s45, 65536
    s_add_u32 s44, s44, s36
    s_lshl_b32 s44, s44, 6
    s_add_u32 s80, s44, 1572864
    v_lshrrev_b32 v4, 3, v1
    v_and_b32 v5, 7, v1
    v_lshlrev_b32 v6, 1, v3
    v_xor_b32 v6, v5, v6
    v_mul_u32_u24 v249, 896, v4
    s_mul_i32 s44, s36, 7168
    s_lshl_b32 s45, s40, 7
    s_add_u32 s44, s44, s45
    v_add_u32 v238, s44, v249
    v_lshl_add_u32 v238, v6, 4, v238
    v_lshl_add_u32 v249, v5, 4, v249
    s_lshl_b32 s44, s39, 3
    s_add_u32 s44, s44, s36
    s_mul_i32 s44, s44, 14336
    s_add_u32 s44, s44, s45
    v_add_u32 v249, s44, v249
    s_mul_i32 s44, s36, 2304
    s_add_u32 s44, s44, 115456
    v_mul_u32_u24 v246, 144, v4
    v_lshl_add_u32 v246, v5, 4, v246
    v_add_u32 v246, s44, v246
    v_mul_u32_u24 v245, 144, v2
    v_lshl_add_u32 v245, v3, 3, v245
    v_add_u32 v245, s44, v245
    v_lshrrev_b32 v4, 2, v2
    v_lshl_add_u32 v5, v3, 2, v4
    v_lshlrev_b32 v5, 7, v5
    v_and_b32 v6, 3, v2
    v_lshl_add_u32 v5, v6, 3, v5
    v_lshrrev_b32 v4, 1, v4
    v_and_b32 v6, 1, v3
    v_lshl_or_b32 v4, v6, 1, v4
    v_lshl_add_u32 v240, v4, 5, v5
    v_xor_b32 v241, 32, v240
    v_xor_b32 v242, 64, v240
    v_xor_b32 v243, 96, v240
    s_mov_b32 s56, 0xaaaaaaaa
    s_mov_b32 s57, 0xaaaaaaaa
    s_mov_b32 s84, 1049335798
    v_mov_b32 v216, 0x3f803f80
    v_mov_b32 v217, 0x3f803f80
    v_mov_b32 v218, 0x3f803f80
    v_mov_b32 v219, 0x3f803f80
    v_and_b32 v4, 1, v2
    v_lshlrev_b32 v226, 4, v4
    v_lshl_add_u32 v5, v3, 2, v4
    v_mov_b32 v6, 0xf149f2ca
    v_cmp_le_u32 vcc, v5, v2
    v_add_u32 v7, 2, v5
    s_nop 0
    v_cndmask_b32 v222, v6, 0, vcc
    v_cmp_le_u32 vcc, v7, v2
    v_add_u32 v8, 2, v2
    s_nop 0
    v_cndmask_b32 v223, v6, 0, vcc
    v_cmp_ge_u32 vcc, v5, v8
    s_nop 1
    v_cndmask_b32 v220, v6, 0, vcc
    v_cmp_ge_u32 vcc, v7, v8
    s_nop 1
    v_cndmask_b32 v221, v6, 0, vcc
    s_or_b32 s44, s39, s37
    s_cmp_eq_u32 s44, 0
    s_cselect_b32 s44, 0xf149f2ca, 0
    v_min_f32 v224, s44, v220
    v_min_f32 v225, s44, v221
    s_lshl_b32 s44, s38, 11
    s_add_u32 s45, s44, 141312
    s_add_u32 s44, s44, 137216
    v_add_u32 v227, s45, v236
    s_lshl_b32 s46, s5, 12
    v_add_u32 v227, s46, v227
    s_cmp_eq_u32 s5, 0
    s_cselect_b32 s46, s44, s45
    v_add_u32 v228, s46, v236
    s_lshl_b32 s46, s5, 10
    s_add_u32 s44, s44, s46
    v_add_u32 v230, s44, v236
    s_waitcnt lgkmcnt(0)
    s_add_u32 s42, s42, 0x7f4a7c15
    s_addc_u32 s43, s43, 0x9e3779b9
    s_cmp_eq_u32 s5, 1
    s_waitcnt lgkmcnt(0)
    s_barrier
    s_mul_i32 s13, s12, 3
    buffer_load_dword v23, v18, s[8:11], s13 offen
    ds_read_b128 v[24:27], v10 offset:0
    ds_read_b64_tr_b16 v[44:45], v14 offset:0
    ds_read_b64_tr_b16 v[46:47], v14 offset:512
    ds_read_b128 v[28:31], v10 offset:2048
    ds_read_b128 v[32:35], v10 offset:4096
    ds_read_b128 v[36:39], v10 offset:6144
    ds_read_b64_tr_b16 v[48:49], v15 offset:0
    ds_read_b64_tr_b16 v[50:51], v15 offset:512
    ds_read_b64_tr_b16 v[52:53], v14 offset:1024
    ds_read_b64_tr_b16 v[54:55], v14 offset:1536
    ds_read_b64_tr_b16 v[56:57], v15 offset:1024
    ds_read_b64_tr_b16 v[58:59], v15 offset:1536
    ds_read_b64_tr_b16 v[60:61], v14 offset:2048
    ds_read_b64_tr_b16 v[62:63], v14 offset:2560
    ds_read_b64_tr_b16 v[64:65], v15 offset:2048
    ds_read_b64_tr_b16 v[66:67], v15 offset:2560
    ds_read_b128 v[40:43], v12 offset:0
    s_waitcnt lgkmcnt(14)
    v_mfma_f32_16x16x32_bf16 v[112:115], v[44:47], v[24:27], 0
    ds_read_b128 v[68:71], v11 offset:0
    s_waitcnt lgkmcnt(14)
    v_mfma_f32_16x16x32_bf16 v[116:119], v[44:47], v[28:31], 0
    ds_read_b64_tr_b16 v[88:89], v14 offset:12288
    s_waitcnt lgkmcnt(14)
    v_mfma_f32_16x16x32_bf16 v[120:123], v[44:47], v[32:35], 0
    ds_read_b64_tr_b16 v[90:91], v14 offset:12800
    s_waitcnt lgkmcnt(14)
    v_mfma_f32_16x16x32_bf16 v[124:127], v[44:47], v[36:39], 0
    ds_read_b128 v[72:75], v11 offset:2048
    s_waitcnt lgkmcnt(13)
    v_mfma_f32_16x16x32_bf16 v[128:131], v[48:51], v[24:27], 0
    ds_read_b128 v[76:79], v11 offset:4096
    v_mfma_f32_16x16x32_bf16 v[132:135], v[48:51], v[28:31], 0
    ds_read_b128 v[80:83], v11 offset:6144
    v_mfma_f32_16x16x32_bf16 v[136:139], v[48:51], v[32:35], 0
    ds_read_b64_tr_b16 v[92:93], v15 offset:12288
    v_mfma_f32_16x16x32_bf16 v[140:143], v[48:51], v[36:39], 0
    ds_read_b64_tr_b16 v[94:95], v15 offset:12800
    s_waitcnt lgkmcnt(15)
    v_mfma_f32_16x16x32_bf16 v[144:147], v[52:55], v[24:27], 0
    ds_read_b64_tr_b16 v[96:97], v14 offset:13312
    v_mfma_f32_16x16x32_bf16 v[148:151], v[52:55], v[28:31], 0
    v_mfma_f32_16x16x32_bf16 v[152:155], v[52:55], v[32:35], 0
    ds_read_b64_tr_b16 v[98:99], v14 offset:13824
    v_mfma_f32_16x16x32_bf16 v[156:159], v[52:55], v[36:39], 0
    ds_read_b64_tr_b16 v[100:101], v15 offset:13312
    s_waitcnt lgkmcnt(15)
    v_mfma_f32_16x16x32_bf16 v[160:163], v[56:59], v[24:27], 0
    ds_read_b64_tr_b16 v[102:103], v15 offset:13824
    v_mfma_f32_16x16x32_bf16 v[164:167], v[56:59], v[28:31], 0
    ds_read_b64_tr_b16 v[104:105], v14 offset:14336
    v_mfma_f32_16x16x32_bf16 v[168:171], v[56:59], v[32:35], 0
    ds_read_b64_tr_b16 v[106:107], v14 offset:14848
    v_mfma_f32_16x16x32_bf16 v[172:175], v[56:59], v[36:39], 0
    ds_read_b64_tr_b16 v[108:109], v15 offset:14336
    s_waitcnt lgkmcnt(15)
    v_mfma_f32_16x16x32_bf16 v[176:179], v[24:27], v[60:63], 0
    ds_read_b64_tr_b16 v[110:111], v15 offset:14848
    v_mfma_f32_16x16x32_bf16 v[180:183], v[28:31], v[60:63], 0
    ds_read_b128 v[84:87], v13 offset:0
    v_mfma_f32_16x16x32_bf16 v[184:187], v[32:35], v[60:63], 0
    v_mfma_f32_16x16x32_bf16 v[188:191], v[36:39], v[60:63], 0
    v_mfma_f32_16x16x32_bf16 v[192:195], v[24:27], v[64:67], 0
    v_mfma_f32_16x16x32_bf16 v[196:199], v[28:31], v[64:67], 0
    v_mfma_f32_16x16x32_bf16 v[200:203], v[32:35], v[64:67], 0
    v_mfma_f32_16x16x32_bf16 v[204:207], v[36:39], v[64:67], 0
    s_cbranch_scc1 L_s_42
    v_mfma_f32_16x16x32_bf16 v[208:211], v[52:55], v[40:43], 0
    v_mfma_f32_16x16x32_bf16 v[212:215], v[56:59], v[40:43], 0
    s_branch L_s_43
L_s_42:
    v_mfma_f32_16x16x32_bf16 v[208:211], v[40:43], v[60:63], 0
    v_mfma_f32_16x16x32_bf16 v[212:215], v[40:43], v[64:67], 0
L_s_43:
    s_waitcnt lgkmcnt(0)
    s_barrier
    s_mul_i32 s13, s12, 4
    buffer_load_dword v23, v18, s[8:11], s13 offen
    v_mfma_f32_16x16x32_bf16 v[112:115], v[88:91], v[68:71], v[112:115]
    ds_read_b128 v[24:27], v10 offset:16384
    v_mfma_f32_16x16x32_bf16 v[116:119], v[88:91], v[72:75], v[116:119]
    ds_read_b64_tr_b16 v[44:45], v14 offset:24576
    v_mfma_f32_16x16x32_bf16 v[120:123], v[88:91], v[76:79], v[120:123]
    ds_read_b64_tr_b16 v[46:47], v14 offset:25088
    v_mfma_f32_16x16x32_bf16 v[124:127], v[88:91], v[80:83], v[124:127]
    v_mfma_f32_16x16x32_bf16 v[128:131], v[92:95], v[68:71], v[128:131]
    ds_read_b128 v[28:31], v10 offset:18432
    v_mfma_f32_16x16x32_bf16 v[132:135], v[92:95], v[72:75], v[132:135]
    ds_read_b128 v[32:35], v10 offset:20480
    v_mfma_f32_16x16x32_bf16 v[136:139], v[92:95], v[76:79], v[136:139]
    ds_read_b128 v[36:39], v10 offset:22528
    v_mfma_f32_16x16x32_bf16 v[140:143], v[92:95], v[80:83], v[140:143]
    v_mfma_f32_16x16x32_bf16 v[144:147], v[96:99], v[68:71], v[144:147]
    ds_read_b64_tr_b16 v[48:49], v15 offset:24576
    v_mfma_f32_16x16x32_bf16 v[148:151], v[96:99], v[72:75], v[148:151]
    ds_read_b64_tr_b16 v[50:51], v15 offset:25088
    v_mfma_f32_16x16x32_bf16 v[152:155], v[96:99], v[76:79], v[152:155]
    ds_read_b64_tr_b16 v[52:53], v14 offset:25600
    v_mfma_f32_16x16x32_bf16 v[156:159], v[96:99], v[80:83], v[156:159]
    v_mfma_f32_16x16x32_bf16 v[160:163], v[100:103], v[68:71], v[160:163]
    ds_read_b64_tr_b16 v[54:55], v14 offset:26112
    v_mfma_f32_16x16x32_bf16 v[164:167], v[100:103], v[72:75], v[164:167]
    ds_read_b64_tr_b16 v[56:57], v15 offset:25600
    v_mfma_f32_16x16x32_bf16 v[168:171], v[100:103], v[76:79], v[168:171]
    ds_read_b64_tr_b16 v[58:59], v15 offset:26112
    v_mfma_f32_16x16x32_bf16 v[172:175], v[100:103], v[80:83], v[172:175]
    v_mfma_f32_16x16x32_bf16 v[176:179], v[68:71], v[104:107], v[176:179]
    ds_read_b64_tr_b16 v[60:61], v14 offset:26624
    v_mfma_f32_16x16x32_bf16 v[180:183], v[72:75], v[104:107], v[180:183]
    ds_read_b64_tr_b16 v[62:63], v14 offset:27136
    v_mfma_f32_16x16x32_bf16 v[184:187], v[76:79], v[104:107], v[184:187]
    ds_read_b64_tr_b16 v[64:65], v15 offset:26624
    v_mfma_f32_16x16x32_bf16 v[188:191], v[80:83], v[104:107], v[188:191]
    v_mfma_f32_16x16x32_bf16 v[192:195], v[68:71], v[108:111], v[192:195]
    ds_read_b64_tr_b16 v[66:67], v15 offset:27136
    v_mfma_f32_16x16x32_bf16 v[196:199], v[72:75], v[108:111], v[196:199]
    ds_read_b128 v[40:43], v12 offset:2048
    v_mfma_f32_16x16x32_bf16 v[200:203], v[76:79], v[108:111], v[200:203]
    v_mfma_f32_16x16x32_bf16 v[204:207], v[80:83], v[108:111], v[204:207]
    s_cbranch_scc1 L_s_44
    v_mfma_f32_16x16x32_bf16 v[208:211], v[96:99], v[84:87], v[208:211]
    v_mfma_f32_16x16x32_bf16 v[212:215], v[100:103], v[84:87], v[212:215]
    s_branch L_s_45
L_s_44:
    v_mfma_f32_16x16x32_bf16 v[208:211], v[84:87], v[104:107], v[208:211]
    v_mfma_f32_16x16x32_bf16 v[212:215], v[84:87], v[108:111], v[212:215]
L_s_45:
    s_waitcnt lgkmcnt(14)
    v_mfma_f32_16x16x32_bf16 v[112:115], v[44:47], v[24:27], v[112:115]
    ds_read_b128 v[68:71], v11 offset:16384
    s_waitcnt lgkmcnt(14)
    v_mfma_f32_16x16x32_bf16 v[116:119], v[44:47], v[28:31], v[116:119]
    ds_read_b64_tr_b16 v[88:89], v14 offset:36864
    s_waitcnt lgkmcnt(14)
    v_mfma_f32_16x16x32_bf16 v[120:123], v[44:47], v[32:35], v[120:123]
    ds_read_b64_tr_b16 v[90:91], v14 offset:37376
    s_waitcnt lgkmcnt(14)
    v_mfma_f32_16x16x32_bf16 v[124:127], v[44:47], v[36:39], v[124:127]
    ds_read_b128 v[72:75], v11 offset:18432
    s_waitcnt lgkmcnt(13)
    v_mfma_f32_16x16x32_bf16 v[128:131], v[48:51], v[24:27], v[128:131]
    ds_read_b128 v[76:79], v11 offset:20480
    v_mfma_f32_16x16x32_bf16 v[132:135], v[48:51], v[28:31], v[132:135]
    ds_read_b128 v[80:83], v11 offset:22528
    v_mfma_f32_16x16x32_bf16 v[136:139], v[48:51], v[32:35], v[136:139]
    ds_read_b64_tr_b16 v[92:93], v15 offset:36864
    v_mfma_f32_16x16x32_bf16 v[140:143], v[48:51], v[36:39], v[140:143]
    ds_read_b64_tr_b16 v[94:95], v15 offset:37376
    s_waitcnt lgkmcnt(15)
    v_mfma_f32_16x16x32_bf16 v[144:147], v[52:55], v[24:27], v[144:147]
    ds_read_b64_tr_b16 v[96:97], v14 offset:37888
    v_mfma_f32_16x16x32_bf16 v[148:151], v[52:55], v[28:31], v[148:151]
    v_mfma_f32_16x16x32_bf16 v[152:155], v[52:55], v[32:35], v[152:155]
    ds_read_b64_tr_b16 v[98:99], v14 offset:38400
    v_mfma_f32_16x16x32_bf16 v[156:159], v[52:55], v[36:39], v[156:159]
    ds_read_b64_tr_b16 v[100:101], v15 offset:37888
    s_waitcnt lgkmcnt(15)
    v_mfma_f32_16x16x32_bf16 v[160:163], v[56:59], v[24:27], v[160:163]
    ds_read_b64_tr_b16 v[102:103], v15 offset:38400
    v_mfma_f32_16x16x32_bf16 v[164:167], v[56:59], v[28:31], v[164:167]
    ds_read_b64_tr_b16 v[104:105], v14 offset:38912
    v_mfma_f32_16x16x32_bf16 v[168:171], v[56:59], v[32:35], v[168:171]
    ds_read_b64_tr_b16 v[106:107], v14 offset:39424
    v_mfma_f32_16x16x32_bf16 v[172:175], v[56:59], v[36:39], v[172:175]
    ds_read_b64_tr_b16 v[108:109], v15 offset:38912
    s_waitcnt lgkmcnt(15)
    v_mfma_f32_16x16x32_bf16 v[176:179], v[24:27], v[60:63], v[176:179]
    ds_read_b64_tr_b16 v[110:111], v15 offset:39424
    v_mfma_f32_16x16x32_bf16 v[180:183], v[28:31], v[60:63], v[180:183]
    ds_read_b128 v[84:87], v13 offset:2048
    v_mfma_f32_16x16x32_bf16 v[184:187], v[32:35], v[60:63], v[184:187]
    v_mfma_f32_16x16x32_bf16 v[188:191], v[36:39], v[60:63], v[188:191]
    v_mfma_f32_16x16x32_bf16 v[192:195], v[24:27], v[64:67], v[192:195]
    v_mfma_f32_16x16x32_bf16 v[196:199], v[28:31], v[64:67], v[196:199]
    v_mfma_f32_16x16x32_bf16 v[200:203], v[32:35], v[64:67], v[200:203]
    v_mfma_f32_16x16x32_bf16 v[204:207], v[36:39], v[64:67], v[204:207]
    s_cbranch_scc1 L_s_46
    v_mfma_f32_16x16x32_bf16 v[208:211], v[52:55], v[40:43], v[208:211]
    v_mfma_f32_16x16x32_bf16 v[212:215], v[56:59], v[40:43], v[212:215]
    s_branch L_s_47
L_s_46:
    v_mfma_f32_16x16x32_bf16 v[208:211], v[40:43], v[60:63], v[208:211]
    v_mfma_f32_16x16x32_bf16 v[212:215], v[40:43], v[64:67], v[212:215]
L_s_47:
    s_waitcnt lgkmcnt(0)
    s_barrier
    s_mul_i32 s13, s12, 5
    buffer_load_dword v23, v18, s[8:11], s13 offen
    v_mfma_f32_16x16x32_bf16 v[112:115], v[88:91], v[68:71], v[112:115]
    ds_read_b128 v[24:27], v10 offset:32768
    v_mfma_f32_16x16x32_bf16 v[116:119], v[88:91], v[72:75], v[116:119]
    ds_read_b64_tr_b16 v[44:45], v16 offset:0
    v_mfma_f32_16x16x32_bf16 v[120:123], v[88:91], v[76:79], v[120:123]
    ds_read_b64_tr_b16 v[46:47], v16 offset:512
    v_mfma_f32_16x16x32_bf16 v[124:127], v[88:91], v[80:83], v[124:127]
    v_mfma_f32_16x16x32_bf16 v[128:131], v[92:95], v[68:71], v[128:131]
    ds_read_b128 v[28:31], v10 offset:34816
    v_mfma_f32_16x16x32_bf16 v[132:135], v[92:95], v[72:75], v[132:135]
    ds_read_b128 v[32:35], v10 offset:36864
    v_mfma_f32_16x16x32_bf16 v[136:139], v[92:95], v[76:79], v[136:139]
    ds_read_b128 v[36:39], v10 offset:38912
    v_mfma_f32_16x16x32_bf16 v[140:143], v[92:95], v[80:83], v[140:143]
    v_mfma_f32_16x16x32_bf16 v[144:147], v[96:99], v[68:71], v[144:147]
    ds_read_b64_tr_b16 v[48:49], v17 offset:0
    v_mfma_f32_16x16x32_bf16 v[148:151], v[96:99], v[72:75], v[148:151]
    ds_read_b64_tr_b16 v[50:51], v17 offset:512
    v_mfma_f32_16x16x32_bf16 v[152:155], v[96:99], v[76:79], v[152:155]
    ds_read_b64_tr_b16 v[52:53], v16 offset:1024
    v_mfma_f32_16x16x32_bf16 v[156:159], v[96:99], v[80:83], v[156:159]
    v_mfma_f32_16x16x32_bf16 v[160:163], v[100:103], v[68:71], v[160:163]
    ds_read_b64_tr_b16 v[54:55], v16 offset:1536
    v_mfma_f32_16x16x32_bf16 v[164:167], v[100:103], v[72:75], v[164:167]
    ds_read_b64_tr_b16 v[56:57], v17 offset:1024
    v_mfma_f32_16x16x32_bf16 v[168:171], v[100:103], v[76:79], v[168:171]
    ds_read_b64_tr_b16 v[58:59], v17 offset:1536
    v_mfma_f32_16x16x32_bf16 v[172:175], v[100:103], v[80:83], v[172:175]
    v_mfma_f32_16x16x32_bf16 v[176:179], v[68:71], v[104:107], v[176:179]
    ds_read_b64_tr_b16 v[60:61], v16 offset:2048
    v_mfma_f32_16x16x32_bf16 v[180:183], v[72:75], v[104:107], v[180:183]
    ds_read_b64_tr_b16 v[62:63], v16 offset:2560
    v_mfma_f32_16x16x32_bf16 v[184:187], v[76:79], v[104:107], v[184:187]
    ds_read_b64_tr_b16 v[64:65], v17 offset:2048
    v_mfma_f32_16x16x32_bf16 v[188:191], v[80:83], v[104:107], v[188:191]
    v_mfma_f32_16x16x32_bf16 v[192:195], v[68:71], v[108:111], v[192:195]
    ds_read_b64_tr_b16 v[66:67], v17 offset:2560
    v_mfma_f32_16x16x32_bf16 v[196:199], v[72:75], v[108:111], v[196:199]
    ds_read_b128 v[40:43], v12 offset:4096
    v_mfma_f32_16x16x32_bf16 v[200:203], v[76:79], v[108:111], v[200:203]
    v_mfma_f32_16x16x32_bf16 v[204:207], v[80:83], v[108:111], v[204:207]
    s_cbranch_scc1 L_s_48
    v_mfma_f32_16x16x32_bf16 v[208:211], v[96:99], v[84:87], v[208:211]
    v_mfma_f32_16x16x32_bf16 v[212:215], v[100:103], v[84:87], v[212:215]
    s_branch L_s_49
L_s_48:
    v_mfma_f32_16x16x32_bf16 v[208:211], v[84:87], v[104:107], v[208:211]
    v_mfma_f32_16x16x32_bf16 v[212:215], v[84:87], v[108:111], v[212:215]
L_s_49:
    s_waitcnt lgkmcnt(14)
    v_mfma_f32_16x16x32_bf16 v[112:115], v[44:47], v[24:27], v[112:115]
    ds_read_b128 v[68:71], v11 offset:32768
    s_waitcnt lgkmcnt(14)
    v_mfma_f32_16x16x32_bf16 v[116:119], v[44:47], v[28:31], v[116:119]
    ds_read_b64_tr_b16 v[88:89], v16 offset:12288
    s_waitcnt lgkmcnt(14)
    v_mfma_f32_16x16x32_bf16 v[120:123], v[44:47], v[32:35], v[120:123]
    ds_read_b64_tr_b16 v[90:91], v16 offset:12800
    s_waitcnt lgkmcnt(14)
    v_mfma_f32_16x16x32_bf16 v[124:127], v[44:47], v[36:39], v[124:127]
    ds_read_b128 v[72:75], v11 offset:34816
    s_waitcnt lgkmcnt(13)
    v_mfma_f32_16x16x32_bf16 v[128:131], v[48:51], v[24:27], v[128:131]
    ds_read_b128 v[76:79], v11 offset:36864
    v_mfma_f32_16x16x32_bf16 v[132:135], v[48:51], v[28:31], v[132:135]
    ds_read_b128 v[80:83], v11 offset:38912
    v_mfma_f32_16x16x32_bf16 v[136:139], v[48:51], v[32:35], v[136:139]
    ds_read_b64_tr_b16 v[92:93], v17 offset:12288
    v_mfma_f32_16x16x32_bf16 v[140:143], v[48:51], v[36:39], v[140:143]
    ds_read_b64_tr_b16 v[94:95], v17 offset:12800
    s_waitcnt lgkmcnt(15)
    v_mfma_f32_16x16x32_bf16 v[144:147], v[52:55], v[24:27], v[144:147]
    ds_read_b64_tr_b16 v[96:97], v16 offset:13312
    v_mfma_f32_16x16x32_bf16 v[148:151], v[52:55], v[28:31], v[148:151]
    v_mfma_f32_16x16x32_bf16 v[152:155], v[52:55], v[32:35], v[152:155]
    ds_read_b64_tr_b16 v[98:99], v16 offset:13824
    v_mfma_f32_16x16x32_bf16 v[156:159], v[52:55], v[36:39], v[156:159]
    ds_read_b64_tr_b16 v[100:101], v17 offset:13312
    s_waitcnt lgkmcnt(15)
    v_mfma_f32_16x16x32_bf16 v[160:163], v[56:59], v[24:27], v[160:163]
    ds_read_b64_tr_b16 v[102:103], v17 offset:13824
    v_mfma_f32_16x16x32_bf16 v[164:167], v[56:59], v[28:31], v[164:167]
    ds_read_b64_tr_b16 v[104:105], v16 offset:14336
    v_mfma_f32_16x16x32_bf16 v[168:171], v[56:59], v[32:35], v[168:171]
    ds_read_b64_tr_b16 v[106:107], v16 offset:14848
    v_mfma_f32_16x16x32_bf16 v[172:175], v[56:59], v[36:39], v[172:175]
    ds_read_b64_tr_b16 v[108:109], v17 offset:14336
    s_waitcnt lgkmcnt(15)
    v_mfma_f32_16x16x32_bf16 v[176:179], v[24:27], v[60:63], v[176:179]
    ds_read_b64_tr_b16 v[110:111], v17 offset:14848
    v_mfma_f32_16x16x32_bf16 v[180:183], v[28:31], v[60:63], v[180:183]
    ds_read_b128 v[84:87], v13 offset:4096
    v_mfma_f32_16x16x32_bf16 v[184:187], v[32:35], v[60:63], v[184:187]
    v_mfma_f32_16x16x32_bf16 v[188:191], v[36:39], v[60:63], v[188:191]
    v_mfma_f32_16x16x32_bf16 v[192:195], v[24:27], v[64:67], v[192:195]
    v_mfma_f32_16x16x32_bf16 v[196:199], v[28:31], v[64:67], v[196:199]
    v_mfma_f32_16x16x32_bf16 v[200:203], v[32:35], v[64:67], v[200:203]
    v_mfma_f32_16x16x32_bf16 v[204:207], v[36:39], v[64:67], v[204:207]
    s_cbranch_scc1 L_s_50
    v_mfma_f32_16x16x32_bf16 v[208:211], v[52:55], v[40:43], v[208:211]
    v_mfma_f32_16x16x32_bf16 v[212:215], v[56:59], v[40:43], v[212:215]
    s_branch L_s_51
L_s_50:
    v_mfma_f32_16x16x32_bf16 v[208:211], v[40:43], v[60:63], v[208:211]
    v_mfma_f32_16x16x32_bf16 v[212:215], v[40:43], v[64:67], v[212:215]
L_s_51:
    s_waitcnt lgkmcnt(0)
    s_barrier
    s_mul_i32 s13, s12, 6
    buffer_load_dword v23, v18, s[8:11], s13 offen
    v_mfma_f32_16x16x32_bf16 v[112:115], v[88:91], v[68:71], v[112:115]
    ds_read_b128 v[24:27], v10 offset:0
    v_mfma_f32_16x16x32_bf16 v[116:119], v[88:91], v[72:75], v[116:119]
    ds_read_b64_tr_b16 v[44:45], v14 offset:0
    v_mfma_f32_16x16x32_bf16 v[120:123], v[88:91], v[76:79], v[120:123]
    ds_read_b64_tr_b16 v[46:47], v14 offset:512
    v_mfma_f32_16x16x32_bf16 v[124:127], v[88:91], v[80:83], v[124:127]
    v_mfma_f32_16x16x32_bf16 v[128:131], v[92:95], v[68:71], v[128:131]
    ds_read_b128 v[28:31], v10 offset:2048
    v_mfma_f32_16x16x32_bf16 v[132:135], v[92:95], v[72:75], v[132:135]
    ds_read_b128 v[32:35], v10 offset:4096
    v_mfma_f32_16x16x32_bf16 v[136:139], v[92:95], v[76:79], v[136:139]
    ds_read_b128 v[36:39], v10 offset:6144
    v_mfma_f32_16x16x32_bf16 v[140:143], v[92:95], v[80:83], v[140:143]
    v_mfma_f32_16x16x32_bf16 v[144:147], v[96:99], v[68:71], v[144:147]
    ds_read_b64_tr_b16 v[48:49], v15 offset:0
    v_mfma_f32_16x16x32_bf16 v[148:151], v[96:99], v[72:75], v[148:151]
    ds_read_b64_tr_b16 v[50:51], v15 offset:512
    v_mfma_f32_16x16x32_bf16 v[152:155], v[96:99], v[76:79], v[152:155]
    ds_read_b64_tr_b16 v[52:53], v14 offset:1024
    v_mfma_f32_16x16x32_bf16 v[156:159], v[96:99], v[80:83], v[156:159]
    v_mfma_f32_16x16x32_bf16 v[160:163], v[100:103], v[68:71], v[160:163]
    ds_read_b64_tr_b16 v[54:55], v14 offset:1536
    v_mfma_f32_16x16x32_bf16 v[164:167], v[100:103], v[72:75], v[164:167]
    ds_read_b64_tr_b16 v[56:57], v15 offset:1024
    v_mfma_f32_16x16x32_bf16 v[168:171], v[100:103], v[76:79], v[168:171]
    ds_read_b64_tr_b16 v[58:59], v15 offset:1536
    v_mfma_f32_16x16x32_bf16 v[172:175], v[100:103], v[80:83], v[172:175]
    v_mfma_f32_16x16x32_bf16 v[176:179], v[68:71], v[104:107], v[176:179]
    ds_read_b64_tr_b16 v[60:61], v14 offset:2048
    v_mfma_f32_16x16x32_bf16 v[180:183], v[72:75], v[104:107], v[180:183]
    ds_read_b64_tr_b16 v[62:63], v14 offset:2560
    v_mfma_f32_16x16x32_bf16 v[184:187], v[76:79], v[104:107], v[184:187]
    ds_read_b64_tr_b16 v[64:65], v15 offset:2048
    v_mfma_f32_16x16x32_bf16 v[188:191], v[80:83], v[104:107], v[188:191]
    v_mfma_f32_16x16x32_bf16 v[192:195], v[68:71], v[108:111], v[192:195]
    ds_read_b64_tr_b16 v[66:67], v15 offset:2560
    v_mfma_f32_16x16x32_bf16 v[196:199], v[72:75], v[108:111], v[196:199]
    ds_read_b128 v[40:43], v12 offset:6144
    v_mfma_f32_16x16x32_bf16 v[200:203], v[76:79], v[108:111], v[200:203]
    v_mfma_f32_16x16x32_bf16 v[204:207], v[80:83], v[108:111], v[204:207]
    s_cbranch_scc1 L_s_52
    v_mfma_f32_16x16x32_bf16 v[208:211], v[96:99], v[84:87], v[208:211]
    v_mfma_f32_16x16x32_bf16 v[212:215], v[100:103], v[84:87], v[212:215]
    s_branch L_s_53
L_s_52:
    v_mfma_f32_16x16x32_bf16 v[208:211], v[84:87], v[104:107], v[208:211]
    v_mfma_f32_16x16x32_bf16 v[212:215], v[84:87], v[108:111], v[212:215]
L_s_53:
    s_waitcnt lgkmcnt(14)
    v_mfma_f32_16x16x32_bf16 v[112:115], v[44:47], v[24:27], v[112:115]
    ds_read_b128 v[68:71], v11 offset:0
    s_waitcnt lgkmcnt(14)
    v_mfma_f32_16x16x32_bf16 v[116:119], v[44:47], v[28:31], v[116:119]
    ds_read_b64_tr_b16 v[88:89], v14 offset:12288
    s_waitcnt lgkmcnt(14)
    v_mfma_f32_16x16x32_bf16 v[120:123], v[44:47], v[32:35], v[120:123]
    ds_read_b64_tr_b16 v[90:91], v14 offset:12800
    s_waitcnt lgkmcnt(14)
    v_mfma_f32_16x16x32_bf16 v[124:127], v[44:47], v[36:39], v[124:127]
    ds_read_b128 v[72:75], v11 offset:2048
    s_waitcnt lgkmcnt(13)
    v_mfma_f32_16x16x32_bf16 v[128:131], v[48:51], v[24:27], v[128:131]
    ds_read_b128 v[76:79], v11 offset:4096
    v_mfma_f32_16x16x32_bf16 v[132:135], v[48:51], v[28:31], v[132:135]
    ds_read_b128 v[80:83], v11 offset:6144
    v_mfma_f32_16x16x32_bf16 v[136:139], v[48:51], v[32:35], v[136:139]
    ds_read_b64_tr_b16 v[92:93], v15 offset:12288
    v_mfma_f32_16x16x32_bf16 v[140:143], v[48:51], v[36:39], v[140:143]
    ds_read_b64_tr_b16 v[94:95], v15 offset:12800
    s_waitcnt lgkmcnt(15)
    v_mfma_f32_16x16x32_bf16 v[144:147], v[52:55], v[24:27], v[144:147]
    ds_read_b64_tr_b16 v[96:97], v14 offset:13312
    v_mfma_f32_16x16x32_bf16 v[148:151], v[52:55], v[28:31], v[148:151]
    v_mfma_f32_16x16x32_bf16 v[152:155], v[52:55], v[32:35], v[152:155]
    ds_read_b64_tr_b16 v[98:99], v14 offset:13824
    v_mfma_f32_16x16x32_bf16 v[156:159], v[52:55], v[36:39], v[156:159]
    ds_read_b64_tr_b16 v[100:101], v15 offset:13312
    s_waitcnt lgkmcnt(15)
    v_mfma_f32_16x16x32_bf16 v[160:163], v[56:59], v[24:27], v[160:163]
    ds_read_b64_tr_b16 v[102:103], v15 offset:13824
    v_mfma_f32_16x16x32_bf16 v[164:167], v[56:59], v[28:31], v[164:167]
    ds_read_b64_tr_b16 v[104:105], v14 offset:14336
    v_mfma_f32_16x16x32_bf16 v[168:171], v[56:59], v[32:35], v[168:171]
    ds_read_b64_tr_b16 v[106:107], v14 offset:14848
    v_mfma_f32_16x16x32_bf16 v[172:175], v[56:59], v[36:39], v[172:175]
    ds_read_b64_tr_b16 v[108:109], v15 offset:14336
    s_waitcnt lgkmcnt(15)
    v_mfma_f32_16x16x32_bf16 v[176:179], v[24:27], v[60:63], v[176:179]
    ds_read_b64_tr_b16 v[110:111], v15 offset:14848
    v_mfma_f32_16x16x32_bf16 v[180:183], v[28:31], v[60:63], v[180:183]
    ds_read_b128 v[84:87], v13 offset:6144
    v_mfma_f32_16x16x32_bf16 v[184:187], v[32:35], v[60:63], v[184:187]
    v_mfma_f32_16x16x32_bf16 v[188:191], v[36:39], v[60:63], v[188:191]
    v_mfma_f32_16x16x32_bf16 v[192:195], v[24:27], v[64:67], v[192:195]
    v_mfma_f32_16x16x32_bf16 v[196:199], v[28:31], v[64:67], v[196:199]
    v_mfma_f32_16x16x32_bf16 v[200:203], v[32:35], v[64:67], v[200:203]
    v_mfma_f32_16x16x32_bf16 v[204:207], v[36:39], v[64:67], v[204:207]
    s_cbranch_scc1 L_s_54
    v_mfma_f32_16x16x32_bf16 v[208:211], v[52:55], v[40:43], v[208:211]
    v_mfma_f32_16x16x32_bf16 v[212:215], v[56:59], v[40:43], v[212:215]
    s_branch L_s_55
L_s_54:
    v_mfma_f32_16x16x32_bf16 v[208:211], v[40:43], v[60:63], v[208:211]
    v_mfma_f32_16x16x32_bf16 v[212:215], v[40:43], v[64:67], v[212:215]
L_s_55:
    s_waitcnt lgkmcnt(0)
    s_barrier
    v_mfma_f32_16x16x32_bf16 v[112:115], v[88:91], v[68:71], v[112:115]
    ds_read_b128 v[24:27], v10 offset:16384
    v_mfma_f32_16x16x32_bf16 v[116:119], v[88:91], v[72:75], v[116:119]
    ds_read_b64_tr_b16 v[44:45], v14 offset:24576
    v_mfma_f32_16x16x32_bf16 v[120:123], v[88:91], v[76:79], v[120:123]
    ds_read_b64_tr_b16 v[46:47], v14 offset:25088
    v_mfma_f32_16x16x32_bf16 v[124:127], v[88:91], v[80:83], v[124:127]
    v_mfma_f32_16x16x32_bf16 v[128:131], v[92:95], v[68:71], v[128:131]
    ds_read_b128 v[28:31], v10 offset:18432
    v_mfma_f32_16x16x32_bf16 v[132:135], v[92:95], v[72:75], v[132:135]
    ds_read_b128 v[32:35], v10 offset:20480
    v_mfma_f32_16x16x32_bf16 v[136:139], v[92:95], v[76:79], v[136:139]
    ds_read_b128 v[36:39], v10 offset:22528
    v_mfma_f32_16x16x32_bf16 v[140:143], v[92:95], v[80:83], v[140:143]
    v_mfma_f32_16x16x32_bf16 v[144:147], v[96:99], v[68:71], v[144:147]
    ds_read_b64_tr_b16 v[48:49], v15 offset:24576
    v_mfma_f32_16x16x32_bf16 v[148:151], v[96:99], v[72:75], v[148:151]
    ds_read_b64_tr_b16 v[50:51], v15 offset:25088
    v_mfma_f32_16x16x32_bf16 v[152:155], v[96:99], v[76:79], v[152:155]
    ds_read_b64_tr_b16 v[52:53], v14 offset:25600
    v_mfma_f32_16x16x32_bf16 v[156:159], v[96:99], v[80:83], v[156:159]
    v_mfma_f32_16x16x32_bf16 v[160:163], v[100:103], v[68:71], v[160:163]
    ds_read_b64_tr_b16 v[54:55], v14 offset:26112
    v_mfma_f32_16x16x32_bf16 v[164:167], v[100:103], v[72:75], v[164:167]
    ds_read_b64_tr_b16 v[56:57], v15 offset:25600
    v_mfma_f32_16x16x32_bf16 v[168:171], v[100:103], v[76:79], v[168:171]
    ds_read_b64_tr_b16 v[58:59], v15 offset:26112
    v_mfma_f32_16x16x32_bf16 v[172:175], v[100:103], v[80:83], v[172:175]
    v_mfma_f32_16x16x32_bf16 v[176:179], v[68:71], v[104:107], v[176:179]
    ds_read_b64_tr_b16 v[60:61], v14 offset:26624
    v_mfma_f32_16x16x32_bf16 v[180:183], v[72:75], v[104:107], v[180:183]
    ds_read_b64_tr_b16 v[62:63], v14 offset:27136
    v_mfma_f32_16x16x32_bf16 v[184:187], v[76:79], v[104:107], v[184:187]
    ds_read_b64_tr_b16 v[64:65], v15 offset:26624
    v_mfma_f32_16x16x32_bf16 v[188:191], v[80:83], v[104:107], v[188:191]
    v_mfma_f32_16x16x32_bf16 v[192:195], v[68:71], v[108:111], v[192:195]
    ds_read_b64_tr_b16 v[66:67], v15 offset:27136
    v_mfma_f32_16x16x32_bf16 v[196:199], v[72:75], v[108:111], v[196:199]
    ds_read_b128 v[40:43], v12 offset:8192
    v_mfma_f32_16x16x32_bf16 v[200:203], v[76:79], v[108:111], v[200:203]
    v_mfma_f32_16x16x32_bf16 v[204:207], v[80:83], v[108:111], v[204:207]
    s_cbranch_scc1 L_s_56
    v_mfma_f32_16x16x32_bf16 v[208:211], v[96:99], v[84:87], v[208:211]
    v_mfma_f32_16x16x32_bf16 v[212:215], v[100:103], v[84:87], v[212:215]
    s_branch L_s_57
L_s_56:
    v_mfma_f32_16x16x32_bf16 v[208:211], v[84:87], v[104:107], v[208:211]
    v_mfma_f32_16x16x32_bf16 v[212:215], v[84:87], v[108:111], v[212:215]
L_s_57:
    s_waitcnt lgkmcnt(14)
    v_mfma_f32_16x16x32_bf16 v[112:115], v[44:47], v[24:27], v[112:115]
    ds_read_b128 v[68:71], v11 offset:16384
    s_waitcnt lgkmcnt(14)
    v_mfma_f32_16x16x32_bf16 v[116:119], v[44:47], v[28:31], v[116:119]
    ds_read_b64_tr_b16 v[88:89], v14 offset:36864
    s_waitcnt lgkmcnt(14)
    v_mfma_f32_16x16x32_bf16 v[120:123], v[44:47], v[32:35], v[120:123]
    ds_read_b64_tr_b16 v[90:91], v14 offset:37376
    s_waitcnt lgkmcnt(14)
    v_mfma_f32_16x16x32_bf16 v[124:127], v[44:47], v[36:39], v[124:127]
    ds_read_b128 v[72:75], v11 offset:18432
    s_waitcnt lgkmcnt(13)
    v_mfma_f32_16x16x32_bf16 v[128:131], v[48:51], v[24:27], v[128:131]
    ds_read_b128 v[76:79], v11 offset:20480
    v_mfma_f32_16x16x32_bf16 v[132:135], v[48:51], v[28:31], v[132:135]
    ds_read_b128 v[80:83], v11 offset:22528
    v_mfma_f32_16x16x32_bf16 v[136:139], v[48:51], v[32:35], v[136:139]
    ds_read_b64_tr_b16 v[92:93], v15 offset:36864
    v_mfma_f32_16x16x32_bf16 v[140:143], v[48:51], v[36:39], v[140:143]
    ds_read_b64_tr_b16 v[94:95], v15 offset:37376
    s_waitcnt lgkmcnt(15)
    v_mfma_f32_16x16x32_bf16 v[144:147], v[52:55], v[24:27], v[144:147]
    ds_read_b64_tr_b16 v[96:97], v14 offset:37888
    v_mfma_f32_16x16x32_bf16 v[148:151], v[52:55], v[28:31], v[148:151]
    v_mfma_f32_16x16x32_bf16 v[152:155], v[52:55], v[32:35], v[152:155]
    ds_read_b64_tr_b16 v[98:99], v14 offset:38400
    v_mfma_f32_16x16x32_bf16 v[156:159], v[52:55], v[36:39], v[156:159]
    ds_read_b64_tr_b16 v[100:101], v15 offset:37888
    s_waitcnt lgkmcnt(15)
    v_mfma_f32_16x16x32_bf16 v[160:163], v[56:59], v[24:27], v[160:163]
    ds_read_b64_tr_b16 v[102:103], v15 offset:38400
    v_mfma_f32_16x16x32_bf16 v[164:167], v[56:59], v[28:31], v[164:167]
    ds_read_b64_tr_b16 v[104:105], v14 offset:38912
    v_mfma_f32_16x16x32_bf16 v[168:171], v[56:59], v[32:35], v[168:171]
    ds_read_b64_tr_b16 v[106:107], v14 offset:39424
    v_mfma_f32_16x16x32_bf16 v[172:175], v[56:59], v[36:39], v[172:175]
    ds_read_b64_tr_b16 v[108:109], v15 offset:38912
    s_waitcnt lgkmcnt(15)
    v_mfma_f32_16x16x32_bf16 v[176:179], v[24:27], v[60:63], v[176:179]
    ds_read_b64_tr_b16 v[110:111], v15 offset:39424
    v_mfma_f32_16x16x32_bf16 v[180:183], v[28:31], v[60:63], v[180:183]
    ds_read_b128 v[84:87], v13 offset:8192
    v_mfma_f32_16x16x32_bf16 v[184:187], v[32:35], v[60:63], v[184:187]
    v_mfma_f32_16x16x32_bf16 v[188:191], v[36:39], v[60:63], v[188:191]
    v_mfma_f32_16x16x32_bf16 v[192:195], v[24:27], v[64:67], v[192:195]
    v_mfma_f32_16x16x32_bf16 v[196:199], v[28:31], v[64:67], v[196:199]
    v_mfma_f32_16x16x32_bf16 v[200:203], v[32:35], v[64:67], v[200:203]
    v_mfma_f32_16x16x32_bf16 v[204:207], v[36:39], v[64:67], v[204:207]
    s_cbranch_scc1 L_s_58
    v_mfma_f32_16x16x32_bf16 v[208:211], v[52:55], v[40:43], v[208:211]
    v_mfma_f32_16x16x32_bf16 v[212:215], v[56:59], v[40:43], v[212:215]
    s_branch L_s_59
L_s_58:
    v_mfma_f32_16x16x32_bf16 v[208:211], v[40:43], v[60:63], v[208:211]
    v_mfma_f32_16x16x32_bf16 v[212:215], v[40:43], v[64:67], v[212:215]
L_s_59:
    s_waitcnt lgkmcnt(0)
    s_barrier
    v_mfma_f32_16x16x32_bf16 v[112:115], v[88:91], v[68:71], v[112:115]
    ds_read_b128 v[24:27], v10 offset:32768
    v_mfma_f32_16x16x32_bf16 v[116:119], v[88:91], v[72:75], v[116:119]
    ds_read_b64_tr_b16 v[44:45], v16 offset:0
    v_mfma_f32_16x16x32_bf16 v[120:123], v[88:91], v[76:79], v[120:123]
    ds_read_b64_tr_b16 v[46:47], v16 offset:512
    v_mfma_f32_16x16x32_bf16 v[124:127], v[88:91], v[80:83], v[124:127]
    v_mfma_f32_16x16x32_bf16 v[128:131], v[92:95], v[68:71], v[128:131]
    ds_read_b128 v[28:31], v10 offset:34816
    v_mfma_f32_16x16x32_bf16 v[132:135], v[92:95], v[72:75], v[132:135]
    ds_read_b128 v[32:35], v10 offset:36864
    v_mfma_f32_16x16x32_bf16 v[136:139], v[92:95], v[76:79], v[136:139]
    ds_read_b128 v[36:39], v10 offset:38912
    v_mfma_f32_16x16x32_bf16 v[140:143], v[92:95], v[80:83], v[140:143]
    v_mfma_f32_16x16x32_bf16 v[144:147], v[96:99], v[68:71], v[144:147]
    ds_read_b64_tr_b16 v[48:49], v17 offset:0
    v_mfma_f32_16x16x32_bf16 v[148:151], v[96:99], v[72:75], v[148:151]
    ds_read_b64_tr_b16 v[50:51], v17 offset:512
    v_mfma_f32_16x16x32_bf16 v[152:155], v[96:99], v[76:79], v[152:155]
    ds_read_b64_tr_b16 v[52:53], v16 offset:1024
    v_mfma_f32_16x16x32_bf16 v[156:159], v[96:99], v[80:83], v[156:159]
    v_mfma_f32_16x16x32_bf16 v[160:163], v[100:103], v[68:71], v[160:163]
    ds_read_b64_tr_b16 v[54:55], v16 offset:1536
    v_mfma_f32_16x16x32_bf16 v[164:167], v[100:103], v[72:75], v[164:167]
    ds_read_b64_tr_b16 v[56:57], v17 offset:1024
    v_mfma_f32_16x16x32_bf16 v[168:171], v[100:103], v[76:79], v[168:171]
    ds_read_b64_tr_b16 v[58:59], v17 offset:1536
    v_mfma_f32_16x16x32_bf16 v[172:175], v[100:103], v[80:83], v[172:175]
    v_mfma_f32_16x16x32_bf16 v[176:179], v[68:71], v[104:107], v[176:179]
    ds_read_b64_tr_b16 v[60:61], v16 offset:2048
    v_mfma_f32_16x16x32_bf16 v[180:183], v[72:75], v[104:107], v[180:183]
    ds_read_b64_tr_b16 v[62:63], v16 offset:2560
    v_mfma_f32_16x16x32_bf16 v[184:187], v[76:79], v[104:107], v[184:187]
    ds_read_b64_tr_b16 v[64:65], v17 offset:2048
    v_mfma_f32_16x16x32_bf16 v[188:191], v[80:83], v[104:107], v[188:191]
    v_mfma_f32_16x16x32_bf16 v[192:195], v[68:71], v[108:111], v[192:195]
    ds_read_b64_tr_b16 v[66:67], v17 offset:2560
    v_mfma_f32_16x16x32_bf16 v[196:199], v[72:75], v[108:111], v[196:199]
    ds_read_b128 v[40:43], v12 offset:10240
    v_mfma_f32_16x16x32_bf16 v[200:203], v[76:79], v[108:111], v[200:203]
    v_mfma_f32_16x16x32_bf16 v[204:207], v[80:83], v[108:111], v[204:207]
    s_cbranch_scc1 L_s_60
    v_mfma_f32_16x16x32_bf16 v[208:211], v[96:99], v[84:87], v[208:211]
    v_mfma_f32_16x16x32_bf16 v[212:215], v[100:103], v[84:87], v[212:215]
    s_branch L_s_61
L_s_60:
    v_mfma_f32_16x16x32_bf16 v[208:211], v[84:87], v[104:107], v[208:211]
    v_mfma_f32_16x16x32_bf16 v[212:215], v[84:87], v[108:111], v[212:215]
L_s_61:
    s_waitcnt lgkmcnt(14)
    v_mfma_f32_16x16x32_bf16 v[112:115], v[44:47], v[24:27], v[112:115]
    ds_read_b128 v[68:71], v11 offset:32768
    s_waitcnt lgkmcnt(14)
    v_mfma_f32_16x16x32_bf16 v[116:119], v[44:47], v[28:31], v[116:119]
    ds_read_b64_tr_b16 v[88:89], v16 offset:12288
    s_waitcnt lgkmcnt(14)
    v_mfma_f32_16x16x32_bf16 v[120:123], v[44:47], v[32:35], v[120:123]
    ds_read_b64_tr_b16 v[90:91], v16 offset:12800
    s_waitcnt lgkmcnt(14)
    v_mfma_f32_16x16x32_bf16 v[124:127], v[44:47], v[36:39], v[124:127]
    ds_read_b128 v[72:75], v11 offset:34816
    s_waitcnt lgkmcnt(13)
    v_mfma_f32_16x16x32_bf16 v[128:131], v[48:51], v[24:27], v[128:131]
    ds_read_b128 v[76:79], v11 offset:36864
    v_mfma_f32_16x16x32_bf16 v[132:135], v[48:51], v[28:31], v[132:135]
    ds_read_b128 v[80:83], v11 offset:38912
    v_mfma_f32_16x16x32_bf16 v[136:139], v[48:51], v[32:35], v[136:139]
    ds_read_b64_tr_b16 v[92:93], v17 offset:12288
    v_mfma_f32_16x16x32_bf16 v[140:143], v[48:51], v[36:39], v[140:143]
    ds_read_b64_tr_b16 v[94:95], v17 offset:12800
    s_waitcnt lgkmcnt(15)
    v_mfma_f32_16x16x32_bf16 v[144:147], v[52:55], v[24:27], v[144:147]
    ds_read_b64_tr_b16 v[96:97], v16 offset:13312
    v_mfma_f32_16x16x32_bf16 v[148:151], v[52:55], v[28:31], v[148:151]
    v_mfma_f32_16x16x32_bf16 v[152:155], v[52:55], v[32:35], v[152:155]
    ds_read_b64_tr_b16 v[98:99], v16 offset:13824
    v_mfma_f32_16x16x32_bf16 v[156:159], v[52:55], v[36:39], v[156:159]
    ds_read_b64_tr_b16 v[100:101], v17 offset:13312
    s_waitcnt lgkmcnt(15)
    v_mfma_f32_16x16x32_bf16 v[160:163], v[56:59], v[24:27], v[160:163]
    ds_read_b64_tr_b16 v[102:103], v17 offset:13824
    v_mfma_f32_16x16x32_bf16 v[164:167], v[56:59], v[28:31], v[164:167]
    ds_read_b64_tr_b16 v[104:105], v16 offset:14336
    v_mfma_f32_16x16x32_bf16 v[168:171], v[56:59], v[32:35], v[168:171]
    ds_read_b64_tr_b16 v[106:107], v16 offset:14848
    v_mfma_f32_16x16x32_bf16 v[172:175], v[56:59], v[36:39], v[172:175]
    ds_read_b64_tr_b16 v[108:109], v17 offset:14336
    s_waitcnt lgkmcnt(15)
    v_mfma_f32_16x16x32_bf16 v[176:179], v[24:27], v[60:63], v[176:179]
    ds_read_b64_tr_b16 v[110:111], v17 offset:14848
    v_mfma_f32_16x16x32_bf16 v[180:183], v[28:31], v[60:63], v[180:183]
    ds_read_b128 v[84:87], v13 offset:10240
    v_mfma_f32_16x16x32_bf16 v[184:187], v[32:35], v[60:63], v[184:187]
    v_mfma_f32_16x16x32_bf16 v[188:191], v[36:39], v[60:63], v[188:191]
    v_mfma_f32_16x16x32_bf16 v[192:195], v[24:27], v[64:67], v[192:195]
    v_mfma_f32_16x16x32_bf16 v[196:199], v[28:31], v[64:67], v[196:199]
    v_mfma_f32_16x16x32_bf16 v[200:203], v[32:35], v[64:67], v[200:203]
    v_mfma_f32_16x16x32_bf16 v[204:207], v[36:39], v[64:67], v[204:207]
    s_cbranch_scc1 L_s_62
    v_mfma_f32_16x16x32_bf16 v[208:211], v[52:55], v[40:43], v[208:211]
    v_mfma_f32_16x16x32_bf16 v[212:215], v[56:59], v[40:43], v[212:215]
    s_branch L_s_63
L_s_62:
    v_mfma_f32_16x16x32_bf16 v[208:211], v[40:43], v[60:63], v[208:211]
    v_mfma_f32_16x16x32_bf16 v[212:215], v[40:43], v[64:67], v[212:215]
L_s_63:
    s_waitcnt lgkmcnt(0)
    s_barrier
    v_mfma_f32_16x16x32_bf16 v[112:115], v[88:91], v[68:71], v[112:115]
    ds_read_b128 v[24:27], v10 offset:0
    v_mfma_f32_16x16x32_bf16 v[116:119], v[88:91], v[72:75], v[116:119]
    ds_read_b64_tr_b16 v[44:45], v14 offset:0
    v_mfma_f32_16x16x32_bf16 v[120:123], v[88:91], v[76:79], v[120:123]
    ds_read_b64_tr_b16 v[46:47], v14 offset:512
    v_mfma_f32_16x16x32_bf16 v[124:127], v[88:91], v[80:83], v[124:127]
    v_mfma_f32_16x16x32_bf16 v[128:131], v[92:95], v[68:71], v[128:131]
    ds_read_b128 v[28:31], v10 offset:2048
    v_mfma_f32_16x16x32_bf16 v[132:135], v[92:95], v[72:75], v[132:135]
    ds_read_b128 v[32:35], v10 offset:4096
    v_mfma_f32_16x16x32_bf16 v[136:139], v[92:95], v[76:79], v[136:139]
    ds_read_b128 v[36:39], v10 offset:6144
    v_mfma_f32_16x16x32_bf16 v[140:143], v[92:95], v[80:83], v[140:143]
    v_mfma_f32_16x16x32_bf16 v[144:147], v[96:99], v[68:71], v[144:147]
    ds_read_b64_tr_b16 v[48:49], v15 offset:0
    v_mfma_f32_16x16x32_bf16 v[148:151], v[96:99], v[72:75], v[148:151]
    ds_read_b64_tr_b16 v[50:51], v15 offset:512
    v_mfma_f32_16x16x32_bf16 v[152:155], v[96:99], v[76:79], v[152:155]
    ds_read_b64_tr_b16 v[52:53], v14 offset:1024
    v_mfma_f32_16x16x32_bf16 v[156:159], v[96:99], v[80:83], v[156:159]
    v_mfma_f32_16x16x32_bf16 v[160:163], v[100:103], v[68:71], v[160:163]
    ds_read_b64_tr_b16 v[54:55], v14 offset:1536
    v_mfma_f32_16x16x32_bf16 v[164:167], v[100:103], v[72:75], v[164:167]
    ds_read_b64_tr_b16 v[56:57], v15 offset:1024
    v_mfma_f32_16x16x32_bf16 v[168:171], v[100:103], v[76:79], v[168:171]
    ds_read_b64_tr_b16 v[58:59], v15 offset:1536
    v_mfma_f32_16x16x32_bf16 v[172:175], v[100:103], v[80:83], v[172:175]
    v_mfma_f32_16x16x32_bf16 v[176:179], v[68:71], v[104:107], v[176:179]
    ds_read_b64_tr_b16 v[60:61], v14 offset:2048
    v_mfma_f32_16x16x32_bf16 v[180:183], v[72:75], v[104:107], v[180:183]
    ds_read_b64_tr_b16 v[62:63], v14 offset:2560
    v_mfma_f32_16x16x32_bf16 v[184:187], v[76:79], v[104:107], v[184:187]
    ds_read_b64_tr_b16 v[64:65], v15 offset:2048
    v_mfma_f32_16x16x32_bf16 v[188:191], v[80:83], v[104:107], v[188:191]
    v_mfma_f32_16x16x32_bf16 v[192:195], v[68:71], v[108:111], v[192:195]
    ds_read_b64_tr_b16 v[66:67], v15 offset:2560
    v_mfma_f32_16x16x32_bf16 v[196:199], v[72:75], v[108:111], v[196:199]
    ds_read_b128 v[40:43], v12 offset:12288
    v_mfma_f32_16x16x32_bf16 v[200:203], v[76:79], v[108:111], v[200:203]
    v_mfma_f32_16x16x32_bf16 v[204:207], v[80:83], v[108:111], v[204:207]
    s_cbranch_scc1 L_s_64
    v_mfma_f32_16x16x32_bf16 v[208:211], v[96:99], v[84:87], v[208:211]
    v_mfma_f32_16x16x32_bf16 v[212:215], v[100:103], v[84:87], v[212:215]
    s_branch L_s_65
L_s_64:
    v_mfma_f32_16x16x32_bf16 v[208:211], v[84:87], v[104:107], v[208:211]
    v_mfma_f32_16x16x32_bf16 v[212:215], v[84:87], v[108:111], v[212:215]
L_s_65:
    s_waitcnt lgkmcnt(14)
    v_mfma_f32_16x16x32_bf16 v[112:115], v[44:47], v[24:27], v[112:115]
    ds_read_b128 v[68:71], v11 offset:0
    s_waitcnt lgkmcnt(14)
    v_mfma_f32_16x16x32_bf16 v[116:119], v[44:47], v[28:31], v[116:119]
    ds_read_b64_tr_b16 v[88:89], v14 offset:12288
    s_waitcnt lgkmcnt(14)
    v_mfma_f32_16x16x32_bf16 v[120:123], v[44:47], v[32:35], v[120:123]
    ds_read_b64_tr_b16 v[90:91], v14 offset:12800
    s_waitcnt lgkmcnt(14)
    v_mfma_f32_16x16x32_bf16 v[124:127], v[44:47], v[36:39], v[124:127]
    ds_read_b128 v[72:75], v11 offset:2048
    s_waitcnt lgkmcnt(13)
    v_mfma_f32_16x16x32_bf16 v[128:131], v[48:51], v[24:27], v[128:131]
    ds_read_b128 v[76:79], v11 offset:4096
    v_mfma_f32_16x16x32_bf16 v[132:135], v[48:51], v[28:31], v[132:135]
    ds_read_b128 v[80:83], v11 offset:6144
    v_mfma_f32_16x16x32_bf16 v[136:139], v[48:51], v[32:35], v[136:139]
    ds_read_b64_tr_b16 v[92:93], v15 offset:12288
    v_mfma_f32_16x16x32_bf16 v[140:143], v[48:51], v[36:39], v[140:143]
    ds_read_b64_tr_b16 v[94:95], v15 offset:12800
    s_waitcnt lgkmcnt(15)
    v_mfma_f32_16x16x32_bf16 v[144:147], v[52:55], v[24:27], v[144:147]
    ds_read_b64_tr_b16 v[96:97], v14 offset:13312
    v_mfma_f32_16x16x32_bf16 v[148:151], v[52:55], v[28:31], v[148:151]
    v_mfma_f32_16x16x32_bf16 v[152:155], v[52:55], v[32:35], v[152:155]
    ds_read_b64_tr_b16 v[98:99], v14 offset:13824
    v_mfma_f32_16x16x32_bf16 v[156:159], v[52:55], v[36:39], v[156:159]
    ds_read_b64_tr_b16 v[100:101], v15 offset:13312
    s_waitcnt lgkmcnt(15)
    v_mfma_f32_16x16x32_bf16 v[160:163], v[56:59], v[24:27], v[160:163]
    ds_read_b64_tr_b16 v[102:103], v15 offset:13824
    v_mfma_f32_16x16x32_bf16 v[164:167], v[56:59], v[28:31], v[164:167]
    ds_read_b64_tr_b16 v[104:105], v14 offset:14336
    v_mfma_f32_16x16x32_bf16 v[168:171], v[56:59], v[32:35], v[168:171]
    ds_read_b64_tr_b16 v[106:107], v14 offset:14848
    v_mfma_f32_16x16x32_bf16 v[172:175], v[56:59], v[36:39], v[172:175]
    ds_read_b64_tr_b16 v[108:109], v15 offset:14336
    s_waitcnt lgkmcnt(15)
    v_mfma_f32_16x16x32_bf16 v[176:179], v[24:27], v[60:63], v[176:179]
    ds_read_b64_tr_b16 v[110:111], v15 offset:14848
    v_mfma_f32_16x16x32_bf16 v[180:183], v[28:31], v[60:63], v[180:183]
    ds_read_b128 v[84:87], v13 offset:12288
    v_mfma_f32_16x16x32_bf16 v[184:187], v[32:35], v[60:63], v[184:187]
    v_mfma_f32_16x16x32_bf16 v[188:191], v[36:39], v[60:63], v[188:191]
    v_mfma_f32_16x16x32_bf16 v[192:195], v[24:27], v[64:67], v[192:195]
    v_mfma_f32_16x16x32_bf16 v[196:199], v[28:31], v[64:67], v[196:199]
    v_mfma_f32_16x16x32_bf16 v[200:203], v[32:35], v[64:67], v[200:203]
    v_mfma_f32_16x16x32_bf16 v[204:207], v[36:39], v[64:67], v[204:207]
    s_cbranch_scc1 L_s_66
    v_mfma_f32_16x16x32_bf16 v[208:211], v[52:55], v[40:43], v[208:211]
    v_mfma_f32_16x16x32_bf16 v[212:215], v[56:59], v[40:43], v[212:215]
    s_branch L_s_67
L_s_66:
    v_mfma_f32_16x16x32_bf16 v[208:211], v[40:43], v[60:63], v[208:211]
    v_mfma_f32_16x16x32_bf16 v[212:215], v[40:43], v[64:67], v[212:215]
L_s_67:
    s_waitcnt lgkmcnt(14)
    v_mfma_f32_16x16x32_bf16 v[112:115], v[88:91], v[68:71], v[112:115]
    s_waitcnt lgkmcnt(13)
    v_mfma_f32_16x16x32_bf16 v[116:119], v[88:91], v[72:75], v[116:119]
    s_waitcnt lgkmcnt(12)
    v_mfma_f32_16x16x32_bf16 v[120:123], v[88:91], v[76:79], v[120:123]
    s_waitcnt lgkmcnt(11)
    v_mfma_f32_16x16x32_bf16 v[124:127], v[88:91], v[80:83], v[124:127]
    s_waitcnt lgkmcnt(9)
    v_mfma_f32_16x16x32_bf16 v[128:131], v[92:95], v[68:71], v[128:131]
    v_mfma_f32_16x16x32_bf16 v[132:135], v[92:95], v[72:75], v[132:135]
    v_mfma_f32_16x16x32_bf16 v[136:139], v[92:95], v[76:79], v[136:139]
    v_mfma_f32_16x16x32_bf16 v[140:143], v[92:95], v[80:83], v[140:143]
    s_waitcnt lgkmcnt(7)
    v_mfma_f32_16x16x32_bf16 v[144:147], v[96:99], v[68:71], v[144:147]
    v_mfma_f32_16x16x32_bf16 v[148:151], v[96:99], v[72:75], v[148:151]
    v_mfma_f32_16x16x32_bf16 v[152:155], v[96:99], v[76:79], v[152:155]
    v_mfma_f32_16x16x32_bf16 v[156:159], v[96:99], v[80:83], v[156:159]
    s_waitcnt lgkmcnt(5)
    v_mfma_f32_16x16x32_bf16 v[160:163], v[100:103], v[68:71], v[160:163]
    v_mfma_f32_16x16x32_bf16 v[164:167], v[100:103], v[72:75], v[164:167]
    v_mfma_f32_16x16x32_bf16 v[168:171], v[100:103], v[76:79], v[168:171]
    v_mfma_f32_16x16x32_bf16 v[172:175], v[100:103], v[80:83], v[172:175]
    s_waitcnt lgkmcnt(3)
    v_mfma_f32_16x16x32_bf16 v[176:179], v[68:71], v[104:107], v[176:179]
    v_mfma_f32_16x16x32_bf16 v[180:183], v[72:75], v[104:107], v[180:183]
    v_mfma_f32_16x16x32_bf16 v[184:187], v[76:79], v[104:107], v[184:187]
    v_mfma_f32_16x16x32_bf16 v[188:191], v[80:83], v[104:107], v[188:191]
    s_waitcnt lgkmcnt(1)
    v_mfma_f32_16x16x32_bf16 v[192:195], v[68:71], v[108:111], v[192:195]
    v_mfma_f32_16x16x32_bf16 v[196:199], v[72:75], v[108:111], v[196:199]
    v_mfma_f32_16x16x32_bf16 v[200:203], v[76:79], v[108:111], v[200:203]
    v_mfma_f32_16x16x32_bf16 v[204:207], v[80:83], v[108:111], v[204:207]
    s_waitcnt lgkmcnt(0)
    s_cbranch_scc1 L_s_68
    v_mfma_f32_16x16x32_bf16 v[208:211], v[96:99], v[84:87], v[208:211]
    v_mfma_f32_16x16x32_bf16 v[212:215], v[100:103], v[84:87], v[212:215]
    s_branch L_s_69
L_s_68:
    v_mfma_f32_16x16x32_bf16 v[208:211], v[84:87], v[104:107], v[208:211]
    v_mfma_f32_16x16x32_bf16 v[212:215], v[84:87], v[108:111], v[212:215]
L_s_69:
    v_cvt_pk_bf16_f32 v40, v156, v157
    v_cvt_pk_bf16_f32 v41, v158, v159
    v_cvt_pk_bf16_f32 v42, v172, v173
    v_cvt_pk_bf16_f32 v43, v174, v175
    ds_write_b128 v227, v[40:43]
    v_cvt_pk_bf16_f32 v68, v188, v189
    v_cvt_pk_bf16_f32 v69, v190, v191
    ds_write_b64 v227, v[68:69] offset:1024
    v_cvt_pk_bf16_f32 v78, v204, v205
    v_cvt_pk_bf16_f32 v79, v206, v207
    ds_write_b64 v227, v[78:79] offset:1032
    v_cvt_pk_bf16_f32 v28, v144, v145
    v_cvt_pk_bf16_f32 v29, v146, v147
    v_cvt_pk_bf16_f32 v30, v160, v161
    v_cvt_pk_bf16_f32 v31, v162, v163
    v_cvt_pk_bf16_f32 v32, v148, v149
    v_cvt_pk_bf16_f32 v33, v150, v151
    v_cvt_pk_bf16_f32 v34, v164, v165
    v_cvt_pk_bf16_f32 v35, v166, v167
    v_cvt_pk_bf16_f32 v36, v152, v153
    v_cvt_pk_bf16_f32 v37, v154, v155
    v_cvt_pk_bf16_f32 v38, v168, v169
    v_cvt_pk_bf16_f32 v39, v170, v171
    v_cvt_pk_bf16_f32 v80, v208, v209
    v_cvt_pk_bf16_f32 v81, v210, v211
    v_cvt_pk_bf16_f32 v82, v212, v213
    v_cvt_pk_bf16_f32 v83, v214, v215
    ds_write_b128 v230, v[80:83]
    v_cvt_pk_bf16_f32 v44, v112, v113
    v_cvt_pk_bf16_f32 v45, v114, v115
    v_cvt_pk_bf16_f32 v46, v128, v129
    v_cvt_pk_bf16_f32 v47, v130, v131
    v_cndmask_b32 v46, 0, v46, s[54:55]
    v_cndmask_b32 v47, 0, v47, s[54:55]
    v_cvt_pk_bf16_f32 v48, v116, v117
    v_cvt_pk_bf16_f32 v49, v118, v119
    v_cvt_pk_bf16_f32 v50, v132, v133
    v_cvt_pk_bf16_f32 v51, v134, v135
    v_cndmask_b32 v50, 0, v50, s[54:55]
    v_cndmask_b32 v51, 0, v51, s[54:55]
    v_cvt_pk_bf16_f32 v52, v120, v121
    v_cvt_pk_bf16_f32 v53, v122, v123
    v_cvt_pk_bf16_f32 v54, v136, v137
    v_cvt_pk_bf16_f32 v55, v138, v139
    v_cndmask_b32 v54, 0, v54, s[54:55]
    v_cndmask_b32 v55, 0, v55, s[54:55]
    v_cvt_pk_bf16_f32 v56, v124, v125
    v_cvt_pk_bf16_f32 v57, v126, v127
    v_cvt_pk_bf16_f32 v58, v140, v141
    v_cvt_pk_bf16_f32 v59, v142, v143
    v_cndmask_b32 v58, 0, v58, s[54:55]
    v_cndmask_b32 v59, 0, v59, s[54:55]
    s_waitcnt lgkmcnt(0)
    s_barrier
    ds_read_b128 v[24:27], v228
    ds_read_b64 v[60:61], v228 offset:1024
    ds_read_b64 v[70:71], v228 offset:1032
    v_cvt_pk_bf16_f32 v62, v176, v177
    v_cvt_pk_bf16_f32 v63, v178, v179
    v_cvt_pk_bf16_f32 v72, v192, v193
    v_cvt_pk_bf16_f32 v73, v194, v195
    v_cvt_pk_bf16_f32 v64, v180, v181
    v_cvt_pk_bf16_f32 v65, v182, v183
    v_cvt_pk_bf16_f32 v74, v196, v197
    v_cvt_pk_bf16_f32 v75, v198, v199
    v_cvt_pk_bf16_f32 v66, v184, v185
    v_cvt_pk_bf16_f32 v67, v186, v187
    v_cvt_pk_bf16_f32 v76, v200, v201
    v_cvt_pk_bf16_f32 v77, v202, v203
    v_mfma_f32_16x16x32_bf16 v[168:171], v[36:39], v[56:59], 0
    v_mfma_f32_16x16x32_bf16 v[172:175], v[40:43], v[56:59], 0
    v_mfma_f32_16x16x32_bf16 v[140:143], v[32:35], v[52:55], 0
    v_mfma_f32_16x16x32_bf16 v[144:147], v[36:39], v[52:55], 0
    v_mfma_f32_16x16x32_bf16 v[112:115], v[28:31], v[48:51], 0
    v_mfma_f32_16x16x32_bf16 v[116:119], v[32:35], v[48:51], 0
    v_mfma_f32_16x16x32_bf16 v[88:91], v[28:31], v[44:47], 0
    s_waitcnt lgkmcnt(0)
    v_mfma_f32_16x16x32_bf16 v[84:87], v[24:27], v[44:47], 0
    v_cndmask_b32 v176, v168, v169, s[56:57]
    v_cndmask_b32 v177, v170, v171, s[56:57]
    v_cndmask_b32 v178, v172, v173, s[56:57]
    v_cndmask_b32 v179, v174, v175, s[56:57]
    v_fma_f32 v176, v176, s84, v220
    v_fma_f32 v177, v177, s84, v221
    v_fma_f32 v178, v178, s84, v222
    v_fma_f32 v179, v179, s84, v223
    v_max3_f32 v180, v176, v177, v178
    v_max_f32 v180, v180, v179
    v_mov_b32 v181, v180
    v_cndmask_b32 v148, v140, v141, s[56:57]
    v_cndmask_b32 v149, v142, v143, s[56:57]
    v_cndmask_b32 v150, v144, v145, s[56:57]
    v_cndmask_b32 v151, v146, v147, s[56:57]
    v_fma_f32 v148, v148, s84, v220
    v_fma_f32 v149, v149, s84, v221
    v_fma_f32 v150, v150, s84, v222
    v_fma_f32 v151, v151, s84, v223
    v_max3_f32 v152, v148, v149, v150
    v_max_f32 v152, v152, v151
    v_mov_b32 v153, v152
    v_cndmask_b32 v120, v112, v113, s[56:57]
    v_cndmask_b32 v121, v114, v115, s[56:57]
    v_cndmask_b32 v122, v116, v117, s[56:57]
    v_cndmask_b32 v123, v118, v119, s[56:57]
    v_fma_f32 v120, v120, s84, v220
    v_fma_f32 v121, v121, s84, v221
    v_fma_f32 v122, v122, s84, v222
    v_fma_f32 v123, v123, s84, v223
    v_max3_f32 v124, v120, v121, v122
    v_max_f32 v124, v124, v123
    v_mov_b32 v125, v124
    v_cndmask_b32 v92, v84, v85, s[56:57]
    v_cndmask_b32 v93, v86, v87, s[56:57]
    v_cndmask_b32 v94, v88, v89, s[56:57]
    v_cndmask_b32 v95, v90, v91, s[56:57]
    v_fma_f32 v92, v92, s84, v224
    v_fma_f32 v93, v93, s84, v225
    v_fma_f32 v94, v94, s84, v222
    v_fma_f32 v95, v95, s84, v223
    v_max3_f32 v96, v92, v93, v94
    v_max_f32 v96, v96, v95
    v_mov_b32 v97, v96
    v_permlane32_swap_b32 v180, v181
    v_permlane32_swap_b32 v152, v153
    v_permlane32_swap_b32 v124, v125
    v_permlane32_swap_b32 v96, v97
    v_max_f32 v180, v180, v181
    v_max_f32 v152, v152, v153
    v_max_f32 v124, v124, v125
    v_max_f32 v96, v96, v97
    v_mov_b32 v181, v180
    v_mov_b32 v153, v152
    v_mov_b32 v125, v124
    v_mov_b32 v97, v96
    v_permlane16_swap_b32 v180, v181
    v_permlane16_swap_b32 v152, v153
    v_permlane16_swap_b32 v124, v125
    v_permlane16_swap_b32 v96, v97
    v_max_f32 v180, v180, v181
    v_max_f32 v152, v152, v153
    v_max_f32 v124, v124, v125
    v_max_f32 v96, v96, v97
    v_sub_f32 v176, v176, v180
    v_sub_f32 v177, v177, v180
    v_sub_f32 v178, v178, v180
    v_sub_f32 v179, v179, v180
    v_exp_f32 v176, v176
    v_exp_f32 v177, v177
    v_exp_f32 v178, v178
    v_exp_f32 v179, v179
    v_sub_f32 v148, v148, v152
    v_sub_f32 v149, v149, v152
    v_sub_f32 v150, v150, v152
    v_sub_f32 v151, v151, v152
    v_exp_f32 v148, v148
    v_exp_f32 v149, v149
    v_exp_f32 v150, v150
    v_exp_f32 v151, v151
    v_sub_f32 v120, v120, v124
    v_sub_f32 v121, v121, v124
    v_sub_f32 v122, v122, v124
    v_sub_f32 v123, v123, v124
    v_exp_f32 v120, v120
    v_exp_f32 v121, v121
    v_exp_f32 v122, v122
    v_exp_f32 v123, v123
    v_sub_f32 v92, v92, v96
    v_sub_f32 v93, v93, v96
    v_sub_f32 v94, v94, v96
    v_sub_f32 v95, v95, v96
    v_exp_f32 v92, v92
    v_exp_f32 v93, v93
    v_exp_f32 v94, v94
    v_exp_f32 v95, v95
    v_cvt_pk_bf16_f32 v184, v176, 0
    v_cvt_pk_bf16_f32 v185, v177, 0
    v_cvt_pk_bf16_f32 v186, v178, 0
    v_cvt_pk_bf16_f32 v187, v179, 0
    v_lshlrev_b32 v184, v226, v184
    v_lshlrev_b32 v185, v226, v185
    v_lshlrev_b32 v186, v226, v186
    v_lshlrev_b32 v187, v226, v187
    v_cvt_pk_bf16_f32 v156, v148, 0
    v_cvt_pk_bf16_f32 v157, v149, 0
    v_cvt_pk_bf16_f32 v158, v150, 0
    v_cvt_pk_bf16_f32 v159, v151, 0
    v_lshlrev_b32 v156, v226, v156
    v_lshlrev_b32 v157, v226, v157
    v_lshlrev_b32 v158, v226, v158
    v_lshlrev_b32 v159, v226, v159
    v_mfma_f32_16x16x32_bf16 v[188:191], v[216:219], v[184:187], 0
    v_mfma_f32_16x16x32_bf16 v[168:171], v[66:69], v[184:187], 0
    v_mfma_f32_16x16x32_bf16 v[172:175], v[76:79], v[184:187], 0
    v_cvt_pk_bf16_f32 v128, v120, 0
    v_cvt_pk_bf16_f32 v129, v121, 0
    v_cvt_pk_bf16_f32 v130, v122, 0
    v_cvt_pk_bf16_f32 v131, v123, 0
    v_lshlrev_b32 v128, v226, v128
    v_lshlrev_b32 v129, v226, v129
    v_lshlrev_b32 v130, v226, v130
    v_lshlrev_b32 v131, v226, v131
    v_mfma_f32_16x16x32_bf16 v[160:163], v[216:219], v[156:159], 0
    v_mfma_f32_16x16x32_bf16 v[140:143], v[64:67], v[156:159], 0
    v_mfma_f32_16x16x32_bf16 v[144:147], v[74:77], v[156:159], 0
    v_cvt_pk_bf16_f32 v100, v92, 0
    v_cvt_pk_bf16_f32 v101, v93, 0
    v_cvt_pk_bf16_f32 v102, v94, 0
    v_cvt_pk_bf16_f32 v103, v95, 0
    v_lshlrev_b32 v100, v226, v100
    v_lshlrev_b32 v101, v226, v101
    v_lshlrev_b32 v102, v226, v102
    v_lshlrev_b32 v103, v226, v103
    v_mfma_f32_16x16x32_bf16 v[132:135], v[216:219], v[128:131], 0
    v_mfma_f32_16x16x32_bf16 v[112:115], v[62:65], v[128:131], 0
    v_mfma_f32_16x16x32_bf16 v[116:119], v[72:75], v[128:131], 0
    s_nop 1
    v_mfma_f32_16x16x32_bf16 v[104:107], v[216:219], v[100:103], 0
    v_mfma_f32_16x16x32_bf16 v[84:87], v[60:63], v[100:103], 0
    v_mfma_f32_16x16x32_bf16 v[88:91], v[70:73], v[100:103], 0
    v_rcp_f32 v180, v188
    s_add_u32 s44, s76, 49152
    v_mul_f32 v168, v168, v180
    v_mul_f32 v169, v169, v180
    v_mul_f32 v170, v170, v180
    v_mul_f32 v171, v171, v180
    v_mul_f32 v172, v172, v180
    v_mul_f32 v173, v173, v180
    v_mul_f32 v174, v174, v180
    v_mul_f32 v175, v175, v180
    v_cvt_pk_bf16_f32 v192, v168, v169
    v_cvt_pk_bf16_f32 v193, v170, v171
    v_cvt_pk_bf16_f32 v194, v172, v173
    v_cvt_pk_bf16_f32 v195, v174, v175
    v_cndmask_b32 v194, 0, v194, s[54:55]
    v_cndmask_b32 v195, 0, v195, s[54:55]
    buffer_store_dwordx4 v[192:195], v236, s[16:19], s44 offen sc1
    v_rcp_f32 v152, v160
    s_add_u32 s44, s76, 32768
    v_mul_f32 v140, v140, v152
    v_mul_f32 v141, v141, v152
    v_mul_f32 v142, v142, v152
    v_mul_f32 v143, v143, v152
    v_mul_f32 v144, v144, v152
    v_mul_f32 v145, v145, v152
    v_mul_f32 v146, v146, v152
    v_mul_f32 v147, v147, v152
    v_cvt_pk_bf16_f32 v164, v140, v141
    v_cvt_pk_bf16_f32 v165, v142, v143
    v_cvt_pk_bf16_f32 v166, v144, v145
    v_cvt_pk_bf16_f32 v167, v146, v147
    v_cndmask_b32 v166, 0, v166, s[54:55]
    v_cndmask_b32 v167, 0, v167, s[54:55]
    buffer_store_dwordx4 v[164:167], v236, s[16:19], s44 offen sc1
    v_rcp_f32 v124, v132
    s_add_u32 s44, s76, 16384
    v_mul_f32 v112, v112, v124
    v_mul_f32 v113, v113, v124
    v_mul_f32 v114, v114, v124
    v_mul_f32 v115, v115, v124
    v_mul_f32 v116, v116, v124
    v_mul_f32 v117, v117, v124
    v_mul_f32 v118, v118, v124
    v_mul_f32 v119, v119, v124
    v_cvt_pk_bf16_f32 v136, v112, v113
    v_cvt_pk_bf16_f32 v137, v114, v115
    v_cvt_pk_bf16_f32 v138, v116, v117
    v_cvt_pk_bf16_f32 v139, v118, v119
    v_cndmask_b32 v138, 0, v138, s[54:55]
    v_cndmask_b32 v139, 0, v139, s[54:55]
    buffer_store_dwordx4 v[136:139], v236, s[16:19], s44 offen sc1
    v_rcp_f32 v96, v104
    s_nop 0
    v_mul_f32 v84, v84, v96
    v_mul_f32 v85, v85, v96
    v_mul_f32 v86, v86, v96
    v_mul_f32 v87, v87, v96
    v_mul_f32 v88, v88, v96
    v_mul_f32 v89, v89, v96
    v_mul_f32 v90, v90, v96
    v_mul_f32 v91, v91, v96
    v_cvt_pk_bf16_f32 v108, v84, v85
    v_cvt_pk_bf16_f32 v109, v86, v87
    v_cvt_pk_bf16_f32 v110, v88, v89
    v_cvt_pk_bf16_f32 v111, v90, v91
    v_cndmask_b32 v110, 0, v110, s[54:55]
    v_cndmask_b32 v111, 0, v111, s[54:55]
    buffer_store_dwordx4 v[108:111], v236, s[16:19], s76 offen sc1
    s_barrier
    v_mov_b32 v24, s42
    v_mov_b32 v25, s43
    v_lshlrev_b32 v26, 9, v1
    s_waitcnt vmcnt(0)
    s_mov_b64 exec, 3
    buffer_store_dwordx2 v[24:25], v26, s[16:19], s77 offen sc1
    s_mov_b64 exec, -1
    s_cmp_eq_u32 s40, 7
    s_cbranch_scc1 L_idle2
    s_branch L_phase2
L_cB:
    v_lshrrev_b32 v9, 1, v2
    v_xor_b32 v9, v3, v9
    v_lshlrev_b32 v9, 4, v9
    v_lshl_add_u32 v9, v2, 7, v9
    s_lshl_b32 s45, s5, 13
    v_add_u32 v10, s45, v9
    v_xor_b32 v11, 64, v10
    v_add_u32 v12, 65536, v10
    v_add_u32 v13, 65536, v11
    v_and_b32 v4, 3, v2
    v_lshlrev_b32 v4, 3, v4
    s_mul_i32 s44, s38, 56
    v_add_u32 v4, s44, v4
    v_and_b32 v5, 8, v2
    v_lshlrev_b32 v5, 2, v5
    v_xor_b32 v4, v4, v5
    v_and_b32 v5, 1, v3
    v_lshlrev_b32 v5, 6, v5
    v_xor_b32 v4, v4, v5
    v_lshrrev_b32 v5, 2, v2
    v_lshl_add_u32 v4, v5, 7, v4
    v_mul_u32_u24 v5, 2048, v3
    v_add_u32 v4, v4, v5
    v_add_u32 v14, 114688, v4
    v_and_b32 v4, 3, v2
    v_lshlrev_b32 v4, 3, v4
    s_mul_i32 s44, s38, 56
    s_add_u32 s44, s44, 32
    v_add_u32 v4, s44, v4
    v_and_b32 v5, 8, v2
    v_lshlrev_b32 v5, 2, v5
    v_xor_b32 v4, v4, v5
    v_and_b32 v5, 1, v3
    v_lshlrev_b32 v5, 6, v5
    v_xor_b32 v4, v4, v5
    v_lshrrev_b32 v5, 2, v2
    v_lshl_add_u32 v4, v5, 7, v4
    v_mul_u32_u24 v5, 2048, v3
    v_add_u32 v4, v4, v5
    v_add_u32 v15, 114688, v4
    s_waitcnt lgkmcnt(0)
    s_cmp_lt_u32 s65, 20
    s_cselect_b32 s8, s78, s84
    s_cselect_b32 s9, s79, s85
    s_cselect_b32 s46, 8, 20
    s_mov_b32 s10, 1204224
    s_mov_b32 s47, 172032
    s_cmp_lt_u32 s65, 8
    s_cselect_b32 s8, s76, s8
    s_cselect_b32 s9, s77, s9
    s_cselect_b32 s10, 1835008, s10
    s_mov_b32 s11, 0x00020000
    s_cselect_b32 s47, 128, s47
    s_cselect_b32 s46, 0, s46
    s_cselect_b64 vcc, -1, 0
    s_sub_u32 s46, s65, s46
    s_lshl_b32 s46, s46, 6
    s_lshl_b32 s45, s4, 4
    s_add_u32 s46, s46, s45
    v_lshrrev_b32 v6, 2, v1
    v_add_u32 v6, s46, v6
    s_lshr_b32 s45, s39, 2
    s_lshl_b32 s45, s45, 9
    v_add_u32 v7, s45, v6
    v_mul_u32_u24 v7, 896, v7
    v_mul_u32_u24 v8, 43691, v6
    v_lshrrev_b32 v8, 19, v8
    v_mul_u32_u24 v4, 12, v8
    v_sub_u32 v6, v6, v4
    v_mul_u32_u24 v8, 2688, v8
    v_lshrrev_b32 v4, 2, v6
    v_mul_u32_u24 v4, 896, v4
    v_add_u32 v8, v8, v4
    v_and_b32 v6, 3, v6
    v_lshl_add_u32 v8, v6, 7, v8
    s_mul_i32 s45, s63, 384
    v_add_u32 v8, s45, v8
    v_cndmask_b32 v8, v8, v7, vcc
    v_mov_b32 v18, v8
    s_mov_b32 s12, s47
    s_mul_i32 s13, s12, 1
    buffer_load_dword v23, v18, s[8:11], s13 offen
    s_mul_i32 s13, s12, 2
    buffer_load_dword v23, v18, s[8:11], s13 offen
    s_mov_b32 s16, s94
    s_mov_b32 s17, s95
    s_mov_b32 s18, 8388608
    s_mov_b32 s19, 0x00020000
    s_load_dwordx2 s[42:43], s[94:95], 0
    s_mov_b32 s20, s80
    s_mov_b32 s21, s81
    s_mov_b32 s22, 401408
    s_mov_b32 s23, 0x00020000
    s_mov_b32 s24, s86
    s_mov_b32 s25, s87
    s_mov_b32 s26, 401408
    s_mov_b32 s27, 0x00020000
    s_mov_b32 s28, s90
    s_mov_b32 s29, s91
    s_mov_b32 s30, 1835008
    s_mov_b32 s31, 0x00020000
    s_mov_b32 s32, s88
    s_mov_b32 s33, s89
    s_mov_b32 s34, 896
    s_mov_b32 s35, 0x00020000
    s_mov_b32 s54, -1
    s_mov_b32 s55, 0xffff
    v_lshlrev_b32 v236, 4, v1
    v_lshlrev_b32 v237, 5, v2
    v_lshlrev_b32 v244, 2, v2
    s_lshl_b32 s44, s39, 1
    s_add_u32 s44, s44, 1
    s_sub_u32 s44, s44, s41
    s_lshl_b32 s44, s44, 2
    s_add_u32 s44, s44, s37
    s_lshl_b32 s45, s40, 1
    s_add_u32 s45, s45, s38
    s_lshl_b32 s46, s44, 5
    s_add_u32 s46, s46, s45
    s_lshl_b32 s46, s46, 10
    s_add_u32 s76, s46, 2097152
    s_lshl_b32 s46, s44, 4
    s_add_u32 s46, s46, s45
    s_lshl_b32 s46, s46, 5
    s_add_u32 s77, s46, 65536
    s_mov_b32 s58, 0x10001000
    s_mov_b32 s59, 0x10001000
    s_mov_b32 s68, 1069066811
    s_mov_b32 s69, 1069066811
    s_mov_b32 s70, 897988541
    s_mov_b32 s71, 897988541
    s_lshl_b32 s44, s4, 11
    s_add_u32 s45, s44, 149504
    v_add_u32 v217, s45, v236
    s_xor_b32 s45, s44, 4096
    s_add_u32 s45, s45, 149504
    v_add_u32 v218, s45, v236
    v_mov_b32 v216, 161792
    s_lshl_b32 s45, s4, 2
    v_add_u32 v219, s45, v216
    s_lshl_b32 s45, s38, 2
    s_add_u32 s45, s45, 16
    v_add_u32 v223, s45, v216
    v_mov_b32 v250, 1
    s_lshl_b32 s44, s40, 2
    s_add_u32 s44, s44, s4
    s_lshl_b32 s45, s44, 14
    s_add_u32 s81, s45, 262144
    s_lshl_b32 s45, s44, 9
    s_add_u32 s83, s45, 4096
    s_lshl_b32 s45, s39, 5
    s_add_u32 s82, s83, s45
    s_lshl_b32 s44, s38, 11
    s_add_u32 s44, s44, 157696
    v_add_u32 v221, s44, v236
    s_lshl_b32 s45, s5, 3
    v_add_u32 v220, s45, v221
    v_lshlrev_b32 v222, 8, v3
    v_add_u32 v222, s44, v222
    s_lshl_b32 s44, s39, 2
    s_add_u32 s44, s44, s4
    s_lshl_b32 s44, s44, 7
    s_add_u32 s86, s44, 1572864
    v_lshrrev_b32 v4, 2, v2
    v_and_b32 v5, 1, v2
    v_lshlrev_b32 v5, 4, v5
    v_mov_b32 v6, 0x3f80
    v_lshlrev_b32 v5, v5, v6
    v_cmp_eq_u32 vcc, v4, v3
    v_and_b32 v6, 2, v2
    s_nop 0
    v_cndmask_b32 v5, 0, v5, vcc
    v_cmp_eq_u32 vcc, 0, v6
    v_mov_b32 v226, 0
    v_mov_b32 v227, 0
    v_mov_b32 v228, 0
    v_mov_b32 v229, 0
    v_cndmask_b32 v224, 0, v5, vcc
    v_cndmask_b32 v225, v5, 0, vcc
    v_mov_b32 v230, v224
    v_mov_b32 v231, v225
    v_mov_b32 v232, s70
    v_mov_b32 v233, s70
    v_mov_b32 v234, s70
    v_mov_b32 v235, s70
    v_lshlrev_b32 v4, 2, v2
    v_add_u32 v4, 161792, v4
    v_mov_b32 v5, 0
    ds_write_b32 v4, v5
    s_waitcnt lgkmcnt(0)
    s_add_u32 s42, s42, 0x7f4a7c15
    s_addc_u32 s43, s43, 0x9e3779b9
    s_waitcnt lgkmcnt(0)
    s_barrier
    s_mul_i32 s13, s12, 3
    buffer_load_dword v23, v18, s[8:11], s13 offen
    ds_read_b128 v[24:27], v10 offset:0
    ds_read_b64_tr_b16 v[40:41], v14 offset:0
    ds_read_b64_tr_b16 v[42:43], v14 offset:512
    ds_read_b128 v[28:31], v10 offset:2048
    ds_read_b128 v[32:35], v10 offset:4096
    ds_read_b128 v[36:39], v10 offset:6144
    ds_read_b64_tr_b16 v[44:45], v15 offset:0
    ds_read_b64_tr_b16 v[46:47], v15 offset:512
    ds_read_b64_tr_b16 v[48:49], v14 offset:1024
    ds_read_b64_tr_b16 v[50:51], v14 offset:1536
    ds_read_b64_tr_b16 v[52:53], v15 offset:1024
    ds_read_b64_tr_b16 v[54:55], v15 offset:1536
    s_waitcnt lgkmcnt(9)
    v_mfma_f32_16x16x32_bf16 v[112:115], v[24:27], v[40:43], v[232:235]
    ds_read_b128 v[56:59], v11 offset:0
    s_waitcnt lgkmcnt(9)
    v_mfma_f32_16x16x32_bf16 v[116:119], v[28:31], v[40:43], v[232:235]
    ds_read_b64_tr_b16 v[72:73], v14 offset:8192
    s_waitcnt lgkmcnt(9)
    v_mfma_f32_16x16x32_bf16 v[120:123], v[32:35], v[40:43], v[232:235]
    ds_read_b64_tr_b16 v[74:75], v14 offset:8704
    s_waitcnt lgkmcnt(9)
    v_mfma_f32_16x16x32_bf16 v[124:127], v[36:39], v[40:43], v[232:235]
    ds_read_b128 v[60:63], v11 offset:2048
    s_waitcnt lgkmcnt(8)
    v_mfma_f32_16x16x32_bf16 v[128:131], v[24:27], v[44:47], v[232:235]
    ds_read_b128 v[64:67], v11 offset:4096
    v_mfma_f32_16x16x32_bf16 v[132:135], v[28:31], v[44:47], v[232:235]
    ds_read_b128 v[68:71], v11 offset:6144
    v_mfma_f32_16x16x32_bf16 v[136:139], v[32:35], v[44:47], v[232:235]
    ds_read_b64_tr_b16 v[76:77], v15 offset:8192
    v_mfma_f32_16x16x32_bf16 v[140:143], v[36:39], v[44:47], v[232:235]
    ds_read_b64_tr_b16 v[78:79], v15 offset:8704
    s_waitcnt lgkmcnt(10)
    v_mfma_f32_16x16x32_bf16 v[144:147], v[24:27], v[48:51], 0
    ds_read_b64_tr_b16 v[80:81], v14 offset:9216
    v_mfma_f32_16x16x32_bf16 v[148:151], v[28:31], v[48:51], 0
    ds_read_b64_tr_b16 v[82:83], v14 offset:9728
    v_mfma_f32_16x16x32_bf16 v[152:155], v[32:35], v[48:51], 0
    ds_read_b64_tr_b16 v[84:85], v15 offset:9216
    v_mfma_f32_16x16x32_bf16 v[156:159], v[36:39], v[48:51], 0
    ds_read_b64_tr_b16 v[86:87], v15 offset:9728
    s_waitcnt lgkmcnt(12)
    v_mfma_f32_16x16x32_bf16 v[160:163], v[24:27], v[52:55], 0
    v_mfma_f32_16x16x32_bf16 v[164:167], v[28:31], v[52:55], 0
    v_mfma_f32_16x16x32_bf16 v[168:171], v[32:35], v[52:55], 0
    v_mfma_f32_16x16x32_bf16 v[172:175], v[36:39], v[52:55], 0
    s_waitcnt lgkmcnt(0)
    s_barrier
    s_mul_i32 s13, s12, 4
    buffer_load_dword v23, v18, s[8:11], s13 offen
    v_mfma_f32_16x16x32_bf16 v[112:115], v[56:59], v[72:75], v[112:115]
    ds_read_b128 v[24:27], v10 offset:16384
    v_mfma_f32_16x16x32_bf16 v[116:119], v[60:63], v[72:75], v[116:119]
    ds_read_b64_tr_b16 v[40:41], v14 offset:16384
    v_mfma_f32_16x16x32_bf16 v[120:123], v[64:67], v[72:75], v[120:123]
    ds_read_b64_tr_b16 v[42:43], v14 offset:16896
    v_mfma_f32_16x16x32_bf16 v[124:127], v[68:71], v[72:75], v[124:127]
    ds_read_b128 v[28:31], v10 offset:18432
    v_mfma_f32_16x16x32_bf16 v[128:131], v[56:59], v[76:79], v[128:131]
    ds_read_b128 v[32:35], v10 offset:20480
    v_mfma_f32_16x16x32_bf16 v[132:135], v[60:63], v[76:79], v[132:135]
    ds_read_b128 v[36:39], v10 offset:22528
    v_mfma_f32_16x16x32_bf16 v[136:139], v[64:67], v[76:79], v[136:139]
    v_mfma_f32_16x16x32_bf16 v[140:143], v[68:71], v[76:79], v[140:143]
    ds_read_b64_tr_b16 v[44:45], v15 offset:16384
    v_mfma_f32_16x16x32_bf16 v[144:147], v[56:59], v[80:83], v[144:147]
    ds_read_b64_tr_b16 v[46:47], v15 offset:16896
    v_mfma_f32_16x16x32_bf16 v[148:151], v[60:63], v[80:83], v[148:151]
    ds_read_b64_tr_b16 v[48:49], v14 offset:17408
    v_mfma_f32_16x16x32_bf16 v[152:155], v[64:67], v[80:83], v[152:155]
    ds_read_b64_tr_b16 v[50:51], v14 offset:17920
    v_mfma_f32_16x16x32_bf16 v[156:159], v[68:71], v[80:83], v[156:159]
    ds_read_b64_tr_b16 v[52:53], v15 offset:17408
    v_mfma_f32_16x16x32_bf16 v[160:163], v[56:59], v[84:87], v[160:163]
    ds_read_b64_tr_b16 v[54:55], v15 offset:17920
    v_mfma_f32_16x16x32_bf16 v[164:167], v[60:63], v[84:87], v[164:167]
    v_mfma_f32_16x16x32_bf16 v[168:171], v[64:67], v[84:87], v[168:171]
    v_mfma_f32_16x16x32_bf16 v[172:175], v[68:71], v[84:87], v[172:175]
    s_waitcnt lgkmcnt(9)
    v_mfma_f32_16x16x32_bf16 v[112:115], v[24:27], v[40:43], v[112:115]
    ds_read_b128 v[56:59], v11 offset:16384
    s_waitcnt lgkmcnt(9)
    v_mfma_f32_16x16x32_bf16 v[116:119], v[28:31], v[40:43], v[116:119]
    ds_read_b64_tr_b16 v[72:73], v14 offset:24576
    s_waitcnt lgkmcnt(9)
    v_mfma_f32_16x16x32_bf16 v[120:123], v[32:35], v[40:43], v[120:123]
    ds_read_b64_tr_b16 v[74:75], v14 offset:25088
    s_waitcnt lgkmcnt(9)
    v_mfma_f32_16x16x32_bf16 v[124:127], v[36:39], v[40:43], v[124:127]
    ds_read_b128 v[60:63], v11 offset:18432
    s_waitcnt lgkmcnt(8)
    v_mfma_f32_16x16x32_bf16 v[128:131], v[24:27], v[44:47], v[128:131]
    ds_read_b128 v[64:67], v11 offset:20480
    v_mfma_f32_16x16x32_bf16 v[132:135], v[28:31], v[44:47], v[132:135]
    ds_read_b128 v[68:71], v11 offset:22528
    v_mfma_f32_16x16x32_bf16 v[136:139], v[32:35], v[44:47], v[136:139]
    ds_read_b64_tr_b16 v[76:77], v15 offset:24576
    v_mfma_f32_16x16x32_bf16 v[140:143], v[36:39], v[44:47], v[140:143]
    ds_read_b64_tr_b16 v[78:79], v15 offset:25088
    s_waitcnt lgkmcnt(10)
    v_mfma_f32_16x16x32_bf16 v[144:147], v[24:27], v[48:51], v[144:147]
    ds_read_b64_tr_b16 v[80:81], v14 offset:25600
    v_mfma_f32_16x16x32_bf16 v[148:151], v[28:31], v[48:51], v[148:151]
    ds_read_b64_tr_b16 v[82:83], v14 offset:26112
    v_mfma_f32_16x16x32_bf16 v[152:155], v[32:35], v[48:51], v[152:155]
    ds_read_b64_tr_b16 v[84:85], v15 offset:25600
    v_mfma_f32_16x16x32_bf16 v[156:159], v[36:39], v[48:51], v[156:159]
    ds_read_b64_tr_b16 v[86:87], v15 offset:26112
    s_waitcnt lgkmcnt(12)
    v_mfma_f32_16x16x32_bf16 v[160:163], v[24:27], v[52:55], v[160:163]
    v_mfma_f32_16x16x32_bf16 v[164:167], v[28:31], v[52:55], v[164:167]
    v_mfma_f32_16x16x32_bf16 v[168:171], v[32:35], v[52:55], v[168:171]
    v_mfma_f32_16x16x32_bf16 v[172:175], v[36:39], v[52:55], v[172:175]
    s_waitcnt lgkmcnt(0)
    s_barrier
    s_mul_i32 s13, s12, 5
    buffer_load_dword v23, v18, s[8:11], s13 offen
    v_mfma_f32_16x16x32_bf16 v[112:115], v[56:59], v[72:75], v[112:115]
    ds_read_b128 v[24:27], v10 offset:32768
    v_mfma_f32_16x16x32_bf16 v[116:119], v[60:63], v[72:75], v[116:119]
    ds_read_b64_tr_b16 v[40:41], v14 offset:0
    v_mfma_f32_16x16x32_bf16 v[120:123], v[64:67], v[72:75], v[120:123]
    ds_read_b64_tr_b16 v[42:43], v14 offset:512
    v_mfma_f32_16x16x32_bf16 v[124:127], v[68:71], v[72:75], v[124:127]
    ds_read_b128 v[28:31], v10 offset:34816
    v_mfma_f32_16x16x32_bf16 v[128:131], v[56:59], v[76:79], v[128:131]
    ds_read_b128 v[32:35], v10 offset:36864
    v_mfma_f32_16x16x32_bf16 v[132:135], v[60:63], v[76:79], v[132:135]
    ds_read_b128 v[36:39], v10 offset:38912
    v_mfma_f32_16x16x32_bf16 v[136:139], v[64:67], v[76:79], v[136:139]
    v_mfma_f32_16x16x32_bf16 v[140:143], v[68:71], v[76:79], v[140:143]
    ds_read_b64_tr_b16 v[44:45], v15 offset:0
    v_mfma_f32_16x16x32_bf16 v[144:147], v[56:59], v[80:83], v[144:147]
    ds_read_b64_tr_b16 v[46:47], v15 offset:512
    v_mfma_f32_16x16x32_bf16 v[148:151], v[60:63], v[80:83], v[148:151]
    ds_read_b64_tr_b16 v[48:49], v14 offset:1024
    v_mfma_f32_16x16x32_bf16 v[152:155], v[64:67], v[80:83], v[152:155]
    ds_read_b64_tr_b16 v[50:51], v14 offset:1536
    v_mfma_f32_16x16x32_bf16 v[156:159], v[68:71], v[80:83], v[156:159]
    ds_read_b64_tr_b16 v[52:53], v15 offset:1024
    v_mfma_f32_16x16x32_bf16 v[160:163], v[56:59], v[84:87], v[160:163]
    ds_read_b64_tr_b16 v[54:55], v15 offset:1536
    v_mfma_f32_16x16x32_bf16 v[164:167], v[60:63], v[84:87], v[164:167]
    v_mfma_f32_16x16x32_bf16 v[168:171], v[64:67], v[84:87], v[168:171]
    v_mfma_f32_16x16x32_bf16 v[172:175], v[68:71], v[84:87], v[172:175]
    s_waitcnt lgkmcnt(9)
    v_mfma_f32_16x16x32_bf16 v[112:115], v[24:27], v[40:43], v[112:115]
    ds_read_b128 v[56:59], v11 offset:32768
    s_waitcnt lgkmcnt(9)
    v_mfma_f32_16x16x32_bf16 v[116:119], v[28:31], v[40:43], v[116:119]
    ds_read_b64_tr_b16 v[72:73], v14 offset:8192
    s_waitcnt lgkmcnt(9)
    v_mfma_f32_16x16x32_bf16 v[120:123], v[32:35], v[40:43], v[120:123]
    ds_read_b64_tr_b16 v[74:75], v14 offset:8704
    s_waitcnt lgkmcnt(9)
    v_mfma_f32_16x16x32_bf16 v[124:127], v[36:39], v[40:43], v[124:127]
    ds_read_b128 v[60:63], v11 offset:34816
    s_waitcnt lgkmcnt(8)
    v_mfma_f32_16x16x32_bf16 v[128:131], v[24:27], v[44:47], v[128:131]
    ds_read_b128 v[64:67], v11 offset:36864
    v_mfma_f32_16x16x32_bf16 v[132:135], v[28:31], v[44:47], v[132:135]
    ds_read_b128 v[68:71], v11 offset:38912
    v_mfma_f32_16x16x32_bf16 v[136:139], v[32:35], v[44:47], v[136:139]
    ds_read_b64_tr_b16 v[76:77], v15 offset:8192
    v_mfma_f32_16x16x32_bf16 v[140:143], v[36:39], v[44:47], v[140:143]
    ds_read_b64_tr_b16 v[78:79], v15 offset:8704
    s_waitcnt lgkmcnt(10)
    v_mfma_f32_16x16x32_bf16 v[144:147], v[24:27], v[48:51], v[144:147]
    ds_read_b64_tr_b16 v[80:81], v14 offset:9216
    v_mfma_f32_16x16x32_bf16 v[148:151], v[28:31], v[48:51], v[148:151]
    ds_read_b64_tr_b16 v[82:83], v14 offset:9728
    v_mfma_f32_16x16x32_bf16 v[152:155], v[32:35], v[48:51], v[152:155]
    ds_read_b64_tr_b16 v[84:85], v15 offset:9216
    v_mfma_f32_16x16x32_bf16 v[156:159], v[36:39], v[48:51], v[156:159]
    ds_read_b64_tr_b16 v[86:87], v15 offset:9728
    s_waitcnt lgkmcnt(12)
    v_mfma_f32_16x16x32_bf16 v[160:163], v[24:27], v[52:55], v[160:163]
    v_mfma_f32_16x16x32_bf16 v[164:167], v[28:31], v[52:55], v[164:167]
    v_mfma_f32_16x16x32_bf16 v[168:171], v[32:35], v[52:55], v[168:171]
    v_mfma_f32_16x16x32_bf16 v[172:175], v[36:39], v[52:55], v[172:175]
    s_waitcnt lgkmcnt(0)
    s_barrier
    s_mul_i32 s13, s12, 6
    buffer_load_dword v23, v18, s[8:11], s13 offen
    v_mfma_f32_16x16x32_bf16 v[112:115], v[56:59], v[72:75], v[112:115]
    ds_read_b128 v[24:27], v10 offset:49152
    v_mfma_f32_16x16x32_bf16 v[116:119], v[60:63], v[72:75], v[116:119]
    ds_read_b64_tr_b16 v[40:41], v14 offset:16384
    v_mfma_f32_16x16x32_bf16 v[120:123], v[64:67], v[72:75], v[120:123]
    ds_read_b64_tr_b16 v[42:43], v14 offset:16896
    v_mfma_f32_16x16x32_bf16 v[124:127], v[68:71], v[72:75], v[124:127]
    ds_read_b128 v[28:31], v10 offset:51200
    v_mfma_f32_16x16x32_bf16 v[128:131], v[56:59], v[76:79], v[128:131]
    ds_read_b128 v[32:35], v10 offset:53248
    v_mfma_f32_16x16x32_bf16 v[132:135], v[60:63], v[76:79], v[132:135]
    ds_read_b128 v[36:39], v10 offset:55296
    v_mfma_f32_16x16x32_bf16 v[136:139], v[64:67], v[76:79], v[136:139]
    v_mfma_f32_16x16x32_bf16 v[140:143], v[68:71], v[76:79], v[140:143]
    ds_read_b64_tr_b16 v[44:45], v15 offset:16384
    v_mfma_f32_16x16x32_bf16 v[144:147], v[56:59], v[80:83], v[144:147]
    ds_read_b64_tr_b16 v[46:47], v15 offset:16896
    v_mfma_f32_16x16x32_bf16 v[148:151], v[60:63], v[80:83], v[148:151]
    ds_read_b64_tr_b16 v[48:49], v14 offset:17408
    v_mfma_f32_16x16x32_bf16 v[152:155], v[64:67], v[80:83], v[152:155]
    ds_read_b64_tr_b16 v[50:51], v14 offset:17920
    v_mfma_f32_16x16x32_bf16 v[156:159], v[68:71], v[80:83], v[156:159]
    ds_read_b64_tr_b16 v[52:53], v15 offset:17408
    v_mfma_f32_16x16x32_bf16 v[160:163], v[56:59], v[84:87], v[160:163]
    ds_read_b64_tr_b16 v[54:55], v15 offset:17920
    v_mfma_f32_16x16x32_bf16 v[164:167], v[60:63], v[84:87], v[164:167]
    v_mfma_f32_16x16x32_bf16 v[168:171], v[64:67], v[84:87], v[168:171]
    v_mfma_f32_16x16x32_bf16 v[172:175], v[68:71], v[84:87], v[172:175]
    s_waitcnt lgkmcnt(9)
    v_mfma_f32_16x16x32_bf16 v[112:115], v[24:27], v[40:43], v[112:115]
    ds_read_b128 v[56:59], v11 offset:49152
    s_waitcnt lgkmcnt(9)
    v_mfma_f32_16x16x32_bf16 v[116:119], v[28:31], v[40:43], v[116:119]
    ds_read_b64_tr_b16 v[72:73], v14 offset:24576
    s_waitcnt lgkmcnt(9)
    v_mfma_f32_16x16x32_bf16 v[120:123], v[32:35], v[40:43], v[120:123]
    ds_read_b64_tr_b16 v[74:75], v14 offset:25088
    s_waitcnt lgkmcnt(9)
    v_mfma_f32_16x16x32_bf16 v[124:127], v[36:39], v[40:43], v[124:127]
    ds_read_b128 v[60:63], v11 offset:51200
    s_waitcnt lgkmcnt(8)
    v_mfma_f32_16x16x32_bf16 v[128:131], v[24:27], v[44:47], v[128:131]
    ds_read_b128 v[64:67], v11 offset:53248
    v_mfma_f32_16x16x32_bf16 v[132:135], v[28:31], v[44:47], v[132:135]
    ds_read_b128 v[68:71], v11 offset:55296
    v_mfma_f32_16x16x32_bf16 v[136:139], v[32:35], v[44:47], v[136:139]
    ds_read_b64_tr_b16 v[76:77], v15 offset:24576
    v_mfma_f32_16x16x32_bf16 v[140:143], v[36:39], v[44:47], v[140:143]
    ds_read_b64_tr_b16 v[78:79], v15 offset:25088
    s_waitcnt lgkmcnt(10)
    v_mfma_f32_16x16x32_bf16 v[144:147], v[24:27], v[48:51], v[144:147]
    ds_read_b64_tr_b16 v[80:81], v14 offset:25600
    v_mfma_f32_16x16x32_bf16 v[148:151], v[28:31], v[48:51], v[148:151]
    ds_read_b64_tr_b16 v[82:83], v14 offset:26112
    v_mfma_f32_16x16x32_bf16 v[152:155], v[32:35], v[48:51], v[152:155]
    ds_read_b64_tr_b16 v[84:85], v15 offset:25600
    v_mfma_f32_16x16x32_bf16 v[156:159], v[36:39], v[48:51], v[156:159]
    ds_read_b64_tr_b16 v[86:87], v15 offset:26112
    s_waitcnt lgkmcnt(12)
    v_mfma_f32_16x16x32_bf16 v[160:163], v[24:27], v[52:55], v[160:163]
    v_mfma_f32_16x16x32_bf16 v[164:167], v[28:31], v[52:55], v[164:167]
    v_mfma_f32_16x16x32_bf16 v[168:171], v[32:35], v[52:55], v[168:171]
    v_mfma_f32_16x16x32_bf16 v[172:175], v[36:39], v[52:55], v[172:175]
    s_waitcnt lgkmcnt(0)
    s_barrier
    v_mfma_f32_16x16x32_bf16 v[112:115], v[56:59], v[72:75], v[112:115]
    ds_read_b128 v[24:27], v12 offset:0
    v_mfma_f32_16x16x32_bf16 v[116:119], v[60:63], v[72:75], v[116:119]
    ds_read_b64_tr_b16 v[40:41], v14 offset:0
    v_mfma_f32_16x16x32_bf16 v[120:123], v[64:67], v[72:75], v[120:123]
    ds_read_b64_tr_b16 v[42:43], v14 offset:512
    v_mfma_f32_16x16x32_bf16 v[124:127], v[68:71], v[72:75], v[124:127]
    ds_read_b128 v[28:31], v12 offset:2048
    v_mfma_f32_16x16x32_bf16 v[128:131], v[56:59], v[76:79], v[128:131]
    ds_read_b128 v[32:35], v12 offset:4096
    v_mfma_f32_16x16x32_bf16 v[132:135], v[60:63], v[76:79], v[132:135]
    ds_read_b128 v[36:39], v12 offset:6144
    v_mfma_f32_16x16x32_bf16 v[136:139], v[64:67], v[76:79], v[136:139]
    v_mfma_f32_16x16x32_bf16 v[140:143], v[68:71], v[76:79], v[140:143]
    ds_read_b64_tr_b16 v[44:45], v15 offset:0
    v_mfma_f32_16x16x32_bf16 v[144:147], v[56:59], v[80:83], v[144:147]
    ds_read_b64_tr_b16 v[46:47], v15 offset:512
    v_mfma_f32_16x16x32_bf16 v[148:151], v[60:63], v[80:83], v[148:151]
    ds_read_b64_tr_b16 v[48:49], v14 offset:1024
    v_mfma_f32_16x16x32_bf16 v[152:155], v[64:67], v[80:83], v[152:155]
    ds_read_b64_tr_b16 v[50:51], v14 offset:1536
    v_mfma_f32_16x16x32_bf16 v[156:159], v[68:71], v[80:83], v[156:159]
    ds_read_b64_tr_b16 v[52:53], v15 offset:1024
    v_mfma_f32_16x16x32_bf16 v[160:163], v[56:59], v[84:87], v[160:163]
    ds_read_b64_tr_b16 v[54:55], v15 offset:1536
    v_mfma_f32_16x16x32_bf16 v[164:167], v[60:63], v[84:87], v[164:167]
    v_mfma_f32_16x16x32_bf16 v[168:171], v[64:67], v[84:87], v[168:171]
    v_mfma_f32_16x16x32_bf16 v[172:175], v[68:71], v[84:87], v[172:175]
    s_waitcnt lgkmcnt(9)
    v_mfma_f32_16x16x32_bf16 v[112:115], v[24:27], v[40:43], v[112:115]
    ds_read_b128 v[56:59], v13 offset:0
    s_waitcnt lgkmcnt(9)
    v_mfma_f32_16x16x32_bf16 v[116:119], v[28:31], v[40:43], v[116:119]
    ds_read_b64_tr_b16 v[72:73], v14 offset:8192
    s_waitcnt lgkmcnt(9)
    v_mfma_f32_16x16x32_bf16 v[120:123], v[32:35], v[40:43], v[120:123]
    ds_read_b64_tr_b16 v[74:75], v14 offset:8704
    s_waitcnt lgkmcnt(9)
    v_mfma_f32_16x16x32_bf16 v[124:127], v[36:39], v[40:43], v[124:127]
    ds_read_b128 v[60:63], v13 offset:2048
    s_waitcnt lgkmcnt(8)
    v_mfma_f32_16x16x32_bf16 v[128:131], v[24:27], v[44:47], v[128:131]
    ds_read_b128 v[64:67], v13 offset:4096
    v_mfma_f32_16x16x32_bf16 v[132:135], v[28:31], v[44:47], v[132:135]
    ds_read_b128 v[68:71], v13 offset:6144
    v_mfma_f32_16x16x32_bf16 v[136:139], v[32:35], v[44:47], v[136:139]
    ds_read_b64_tr_b16 v[76:77], v15 offset:8192
    v_mfma_f32_16x16x32_bf16 v[140:143], v[36:39], v[44:47], v[140:143]
    ds_read_b64_tr_b16 v[78:79], v15 offset:8704
    s_waitcnt lgkmcnt(10)
    v_mfma_f32_16x16x32_bf16 v[144:147], v[24:27], v[48:51], v[144:147]
    ds_read_b64_tr_b16 v[80:81], v14 offset:9216
    v_mfma_f32_16x16x32_bf16 v[148:151], v[28:31], v[48:51], v[148:151]
    ds_read_b64_tr_b16 v[82:83], v14 offset:9728
    v_mfma_f32_16x16x32_bf16 v[152:155], v[32:35], v[48:51], v[152:155]
    ds_read_b64_tr_b16 v[84:85], v15 offset:9216
    v_mfma_f32_16x16x32_bf16 v[156:159], v[36:39], v[48:51], v[156:159]
    ds_read_b64_tr_b16 v[86:87], v15 offset:9728
    s_waitcnt lgkmcnt(12)
    v_mfma_f32_16x16x32_bf16 v[160:163], v[24:27], v[52:55], v[160:163]
    v_mfma_f32_16x16x32_bf16 v[164:167], v[28:31], v[52:55], v[164:167]
    v_mfma_f32_16x16x32_bf16 v[168:171], v[32:35], v[52:55], v[168:171]
    v_mfma_f32_16x16x32_bf16 v[172:175], v[36:39], v[52:55], v[172:175]
    s_waitcnt lgkmcnt(0)
    s_barrier
    v_mfma_f32_16x16x32_bf16 v[112:115], v[56:59], v[72:75], v[112:115]
    ds_read_b128 v[24:27], v12 offset:16384
    v_mfma_f32_16x16x32_bf16 v[116:119], v[60:63], v[72:75], v[116:119]
    ds_read_b64_tr_b16 v[40:41], v14 offset:16384
    v_mfma_f32_16x16x32_bf16 v[120:123], v[64:67], v[72:75], v[120:123]
    ds_read_b64_tr_b16 v[42:43], v14 offset:16896
    v_mfma_f32_16x16x32_bf16 v[124:127], v[68:71], v[72:75], v[124:127]
    ds_read_b128 v[28:31], v12 offset:18432
    v_mfma_f32_16x16x32_bf16 v[128:131], v[56:59], v[76:79], v[128:131]
    ds_read_b128 v[32:35], v12 offset:20480
    v_mfma_f32_16x16x32_bf16 v[132:135], v[60:63], v[76:79], v[132:135]
    ds_read_b128 v[36:39], v12 offset:22528
    v_mfma_f32_16x16x32_bf16 v[136:139], v[64:67], v[76:79], v[136:139]
    v_mfma_f32_16x16x32_bf16 v[140:143], v[68:71], v[76:79], v[140:143]
    ds_read_b64_tr_b16 v[44:45], v15 offset:16384
    v_mfma_f32_16x16x32_bf16 v[144:147], v[56:59], v[80:83], v[144:147]
    ds_read_b64_tr_b16 v[46:47], v15 offset:16896
    v_mfma_f32_16x16x32_bf16 v[148:151], v[60:63], v[80:83], v[148:151]
    ds_read_b64_tr_b16 v[48:49], v14 offset:17408
    v_mfma_f32_16x16x32_bf16 v[152:155], v[64:67], v[80:83], v[152:155]
    ds_read_b64_tr_b16 v[50:51], v14 offset:17920
    v_mfma_f32_16x16x32_bf16 v[156:159], v[68:71], v[80:83], v[156:159]
    ds_read_b64_tr_b16 v[52:53], v15 offset:17408
    v_mfma_f32_16x16x32_bf16 v[160:163], v[56:59], v[84:87], v[160:163]
    ds_read_b64_tr_b16 v[54:55], v15 offset:17920
    v_mfma_f32_16x16x32_bf16 v[164:167], v[60:63], v[84:87], v[164:167]
    v_mfma_f32_16x16x32_bf16 v[168:171], v[64:67], v[84:87], v[168:171]
    v_mfma_f32_16x16x32_bf16 v[172:175], v[68:71], v[84:87], v[172:175]
    s_waitcnt lgkmcnt(9)
    v_mfma_f32_16x16x32_bf16 v[112:115], v[24:27], v[40:43], v[112:115]
    ds_read_b128 v[56:59], v13 offset:16384
    s_waitcnt lgkmcnt(9)
    v_mfma_f32_16x16x32_bf16 v[116:119], v[28:31], v[40:43], v[116:119]
    ds_read_b64_tr_b16 v[72:73], v14 offset:24576
    s_waitcnt lgkmcnt(9)
    v_mfma_f32_16x16x32_bf16 v[120:123], v[32:35], v[40:43], v[120:123]
    ds_read_b64_tr_b16 v[74:75], v14 offset:25088
    s_waitcnt lgkmcnt(9)
    v_mfma_f32_16x16x32_bf16 v[124:127], v[36:39], v[40:43], v[124:127]
    ds_read_b128 v[60:63], v13 offset:18432
    s_waitcnt lgkmcnt(8)
    v_mfma_f32_16x16x32_bf16 v[128:131], v[24:27], v[44:47], v[128:131]
    ds_read_b128 v[64:67], v13 offset:20480
    v_mfma_f32_16x16x32_bf16 v[132:135], v[28:31], v[44:47], v[132:135]
    ds_read_b128 v[68:71], v13 offset:22528
    v_mfma_f32_16x16x32_bf16 v[136:139], v[32:35], v[44:47], v[136:139]
    ds_read_b64_tr_b16 v[76:77], v15 offset:24576
    v_mfma_f32_16x16x32_bf16 v[140:143], v[36:39], v[44:47], v[140:143]
    ds_read_b64_tr_b16 v[78:79], v15 offset:25088
    s_waitcnt lgkmcnt(10)
    v_mfma_f32_16x16x32_bf16 v[144:147], v[24:27], v[48:51], v[144:147]
    ds_read_b64_tr_b16 v[80:81], v14 offset:25600
    v_mfma_f32_16x16x32_bf16 v[148:151], v[28:31], v[48:51], v[148:151]
    ds_read_b64_tr_b16 v[82:83], v14 offset:26112
    v_mfma_f32_16x16x32_bf16 v[152:155], v[32:35], v[48:51], v[152:155]
    ds_read_b64_tr_b16 v[84:85], v15 offset:25600
    v_mfma_f32_16x16x32_bf16 v[156:159], v[36:39], v[48:51], v[156:159]
    ds_read_b64_tr_b16 v[86:87], v15 offset:26112
    s_waitcnt lgkmcnt(12)
    v_mfma_f32_16x16x32_bf16 v[160:163], v[24:27], v[52:55], v[160:163]
    v_mfma_f32_16x16x32_bf16 v[164:167], v[28:31], v[52:55], v[164:167]
    v_mfma_f32_16x16x32_bf16 v[168:171], v[32:35], v[52:55], v[168:171]
    v_mfma_f32_16x16x32_bf16 v[172:175], v[36:39], v[52:55], v[172:175]
    s_waitcnt lgkmcnt(0)
    s_barrier
    v_mfma_f32_16x16x32_bf16 v[112:115], v[56:59], v[72:75], v[112:115]
    ds_read_b128 v[24:27], v12 offset:32768
    v_mfma_f32_16x16x32_bf16 v[116:119], v[60:63], v[72:75], v[116:119]
    ds_read_b64_tr_b16 v[40:41], v14 offset:0
    v_mfma_f32_16x16x32_bf16 v[120:123], v[64:67], v[72:75], v[120:123]
    ds_read_b64_tr_b16 v[42:43], v14 offset:512
    v_mfma_f32_16x16x32_bf16 v[124:127], v[68:71], v[72:75], v[124:127]
    ds_read_b128 v[28:31], v12 offset:34816
    v_mfma_f32_16x16x32_bf16 v[128:131], v[56:59], v[76:79], v[128:131]
    ds_read_b128 v[32:35], v12 offset:36864
    v_mfma_f32_16x16x32_bf16 v[132:135], v[60:63], v[76:79], v[132:135]
    ds_read_b128 v[36:39], v12 offset:38912
    v_mfma_f32_16x16x32_bf16 v[136:139], v[64:67], v[76:79], v[136:139]
    v_mfma_f32_16x16x32_bf16 v[140:143], v[68:71], v[76:79], v[140:143]
    ds_read_b64_tr_b16 v[44:45], v15 offset:0
    v_mfma_f32_16x16x32_bf16 v[144:147], v[56:59], v[80:83], v[144:147]
    ds_read_b64_tr_b16 v[46:47], v15 offset:512
    v_mfma_f32_16x16x32_bf16 v[148:151], v[60:63], v[80:83], v[148:151]
    ds_read_b64_tr_b16 v[48:49], v14 offset:1024
    v_mfma_f32_16x16x32_bf16 v[152:155], v[64:67], v[80:83], v[152:155]
    ds_read_b64_tr_b16 v[50:51], v14 offset:1536
    v_mfma_f32_16x16x32_bf16 v[156:159], v[68:71], v[80:83], v[156:159]
    ds_read_b64_tr_b16 v[52:53], v15 offset:1024
    v_mfma_f32_16x16x32_bf16 v[160:163], v[56:59], v[84:87], v[160:163]
    ds_read_b64_tr_b16 v[54:55], v15 offset:1536
    v_mfma_f32_16x16x32_bf16 v[164:167], v[60:63], v[84:87], v[164:167]
    v_mfma_f32_16x16x32_bf16 v[168:171], v[64:67], v[84:87], v[168:171]
    v_mfma_f32_16x16x32_bf16 v[172:175], v[68:71], v[84:87], v[172:175]
    s_waitcnt lgkmcnt(9)
    v_mfma_f32_16x16x32_bf16 v[112:115], v[24:27], v[40:43], v[112:115]
    ds_read_b128 v[56:59], v13 offset:32768
    ds_read_b64_tr_b16 v[72:73], v14 offset:8192
    s_waitcnt lgkmcnt(10)
    v_mfma_f32_16x16x32_bf16 v[116:119], v[28:31], v[40:43], v[116:119]
    ds_read_b64_tr_b16 v[74:75], v14 offset:8704
    s_waitcnt lgkmcnt(10)
    v_mfma_f32_16x16x32_bf16 v[120:123], v[32:35], v[40:43], v[120:123]
    ds_read_b128 v[60:63], v13 offset:34816
    ds_read_b128 v[64:67], v13 offset:36864
    s_waitcnt lgkmcnt(11)
    v_mfma_f32_16x16x32_bf16 v[124:127], v[36:39], v[40:43], v[124:127]
    ds_read_b128 v[68:71], v13 offset:38912
    s_waitcnt lgkmcnt(10)
    v_mfma_f32_16x16x32_bf16 v[128:131], v[24:27], v[44:47], v[128:131]
    ds_read_b64_tr_b16 v[76:77], v15 offset:8192
    ds_read_b64_tr_b16 v[78:79], v15 offset:8704
    v_mfma_f32_16x16x32_bf16 v[132:135], v[28:31], v[44:47], v[132:135]
    ds_read_b64_tr_b16 v[80:81], v14 offset:9216
    v_mfma_f32_16x16x32_bf16 v[136:139], v[32:35], v[44:47], v[136:139]
    ds_read_b64_tr_b16 v[82:83], v14 offset:9728
    ds_read_b64_tr_b16 v[84:85], v15 offset:9216
    v_mfma_f32_16x16x32_bf16 v[140:143], v[36:39], v[44:47], v[140:143]
    ds_read_b64_tr_b16 v[86:87], v15 offset:9728
    s_waitcnt lgkmcnt(14)
    v_mfma_f32_16x16x32_bf16 v[144:147], v[24:27], v[48:51], v[144:147]
    v_mfma_f32_16x16x32_bf16 v[148:151], v[28:31], v[48:51], v[148:151]
    v_mfma_f32_16x16x32_bf16 v[152:155], v[32:35], v[48:51], v[152:155]
    v_mfma_f32_16x16x32_bf16 v[156:159], v[36:39], v[48:51], v[156:159]
    s_waitcnt lgkmcnt(9)
    v_mfma_f32_16x16x32_bf16 v[112:115], v[56:59], v[72:75], v[112:115]
    s_waitcnt lgkmcnt(8)
    v_mfma_f32_16x16x32_bf16 v[116:119], v[60:63], v[72:75], v[116:119]
    s_waitcnt lgkmcnt(7)
    v_mfma_f32_16x16x32_bf16 v[120:123], v[64:67], v[72:75], v[120:123]
    s_waitcnt lgkmcnt(6)
    v_mfma_f32_16x16x32_bf16 v[124:127], v[68:71], v[72:75], v[124:127]
    s_waitcnt lgkmcnt(4)
    v_mfma_f32_16x16x32_bf16 v[128:131], v[56:59], v[76:79], v[128:131]
    v_mfma_f32_16x16x32_bf16 v[132:135], v[60:63], v[76:79], v[132:135]
    v_mfma_f32_16x16x32_bf16 v[136:139], v[64:67], v[76:79], v[136:139]
    v_mfma_f32_16x16x32_bf16 v[140:143], v[68:71], v[76:79], v[140:143]
    v_mfma_f32_16x16x32_bf16 v[160:163], v[24:27], v[52:55], v[160:163]
    v_mfma_f32_16x16x32_bf16 v[164:167], v[28:31], v[52:55], v[164:167]
    v_mfma_f32_16x16x32_bf16 v[168:171], v[32:35], v[52:55], v[168:171]
    v_mfma_f32_16x16x32_bf16 v[172:175], v[36:39], v[52:55], v[172:175]
    s_nop 3
    v_pk_mul_f32 v[176:177], v[112:113], s[68:69]
    v_pk_mul_f32 v[178:179], v[114:115], s[68:69]
    v_pk_mul_f32 v[180:181], v[116:117], s[68:69]
    v_pk_mul_f32 v[182:183], v[118:119], s[68:69]
    v_pk_mul_f32 v[184:185], v[120:121], s[68:69]
    v_pk_mul_f32 v[186:187], v[122:123], s[68:69]
    v_pk_mul_f32 v[188:189], v[124:125], s[68:69]
    v_pk_mul_f32 v[190:191], v[126:127], s[68:69]
    v_pk_mul_f32 v[192:193], v[128:129], s[68:69]
    v_pk_mul_f32 v[194:195], v[130:131], s[68:69]
    v_pk_mul_f32 v[196:197], v[132:133], s[68:69]
    s_waitcnt lgkmcnt(2)
    v_mfma_f32_16x16x32_bf16 v[144:147], v[56:59], v[80:83], v[144:147]
    v_pk_mul_f32 v[198:199], v[134:135], s[68:69]
    v_pk_mul_f32 v[200:201], v[136:137], s[68:69]
    v_pk_mul_f32 v[202:203], v[138:139], s[68:69]
    v_pk_mul_f32 v[204:205], v[140:141], s[68:69]
    v_pk_mul_f32 v[206:207], v[142:143], s[68:69]
    v_exp_f32 v176, v176 clamp
    v_exp_f32 v177, v177 clamp
    v_exp_f32 v178, v178 clamp
    v_exp_f32 v179, v179 clamp
    v_exp_f32 v180, v180 clamp
    v_exp_f32 v181, v181 clamp
    v_mfma_f32_16x16x32_bf16 v[148:151], v[60:63], v[80:83], v[148:151]
    v_exp_f32 v182, v182 clamp
    v_exp_f32 v183, v183 clamp
    v_exp_f32 v184, v184 clamp
    v_exp_f32 v185, v185 clamp
    v_exp_f32 v186, v186 clamp
    v_exp_f32 v187, v187 clamp
    v_exp_f32 v188, v188 clamp
    v_exp_f32 v189, v189 clamp
    v_exp_f32 v190, v190 clamp
    v_exp_f32 v191, v191 clamp
    v_exp_f32 v192, v192 clamp
    v_mfma_f32_16x16x32_bf16 v[152:155], v[64:67], v[80:83], v[152:155]
    v_exp_f32 v193, v193 clamp
    v_exp_f32 v194, v194 clamp
    v_exp_f32 v195, v195 clamp
    v_exp_f32 v196, v196 clamp
    v_exp_f32 v197, v197 clamp
    v_exp_f32 v198, v198 clamp
    v_exp_f32 v199, v199 clamp
    v_exp_f32 v200, v200 clamp
    v_exp_f32 v201, v201 clamp
    v_exp_f32 v202, v202 clamp
    v_exp_f32 v203, v203 clamp
    v_mfma_f32_16x16x32_bf16 v[156:159], v[68:71], v[80:83], v[156:159]
    v_exp_f32 v204, v204 clamp
    v_exp_f32 v205, v205 clamp
    v_exp_f32 v206, v206 clamp
    v_exp_f32 v207, v207 clamp
    v_max_f32 v112, s70, v112
    v_max_f32 v113, s70, v113
    v_max_f32 v114, s70, v114
    v_max_f32 v115, s70, v115
    v_max_f32 v116, s70, v116
    v_max_f32 v117, s70, v117
    v_max_f32 v118, s70, v118
    s_waitcnt lgkmcnt(0)
    v_mfma_f32_16x16x32_bf16 v[160:163], v[56:59], v[84:87], v[160:163]
    v_max_f32 v119, s70, v119
    v_max_f32 v120, s70, v120
    v_max_f32 v121, s70, v121
    v_max_f32 v122, s70, v122
    v_max_f32 v123, s70, v123
    v_max_f32 v124, s70, v124
    v_max_f32 v125, s70, v125
    v_max_f32 v126, s70, v126
    v_max_f32 v127, s70, v127
    v_max_f32 v128, s70, v128
    v_max_f32 v129, s70, v129
    v_mfma_f32_16x16x32_bf16 v[164:167], v[60:63], v[84:87], v[164:167]
    v_max_f32 v130, s70, v130
    v_max_f32 v131, s70, v131
    v_max_f32 v132, s70, v132
    v_max_f32 v133, s70, v133
    v_max_f32 v134, s70, v134
    v_max_f32 v135, s70, v135
    v_max_f32 v136, s70, v136
    v_max_f32 v137, s70, v137
    v_max_f32 v138, s70, v138
    v_max_f32 v139, s70, v139
    v_max_f32 v140, s70, v140
    v_mfma_f32_16x16x32_bf16 v[168:171], v[64:67], v[84:87], v[168:171]
    v_max_f32 v141, s70, v141
    v_max_f32 v142, s70, v142
    v_max_f32 v143, s70, v143
    v_pk_add_f32 v[112:113], v[112:113], v[176:177]
    v_pk_add_f32 v[114:115], v[114:115], v[178:179]
    v_pk_add_f32 v[116:117], v[116:117], v[180:181]
    v_pk_add_f32 v[118:119], v[118:119], v[182:183]
    v_pk_add_f32 v[120:121], v[120:121], v[184:185]
    v_pk_add_f32 v[122:123], v[122:123], v[186:187]
    v_pk_add_f32 v[124:125], v[124:125], v[188:189]
    v_pk_add_f32 v[126:127], v[126:127], v[190:191]
    v_mfma_f32_16x16x32_bf16 v[172:175], v[68:71], v[84:87], v[172:175]
    v_pk_add_f32 v[128:129], v[128:129], v[192:193]
    v_pk_add_f32 v[130:131], v[130:131], v[194:195]
    v_pk_add_f32 v[132:133], v[132:133], v[196:197]
    v_pk_add_f32 v[134:135], v[134:135], v[198:199]
    v_pk_add_f32 v[136:137], v[136:137], v[200:201]
    v_pk_add_f32 v[138:139], v[138:139], v[202:203]
    v_pk_add_f32 v[140:141], v[140:141], v[204:205]
    v_pk_add_f32 v[142:143], v[142:143], v[206:207]
    v_cvt_pk_bf16_f32 v24, v112, v113
    v_cvt_pk_bf16_f32 v25, v114, v115
    v_cvt_pk_bf16_f32 v26, v116, v117
    v_cvt_pk_bf16_f32 v27, v118, v119
    v_cvt_pk_bf16_f32 v28, v128, v129
    v_cvt_pk_bf16_f32 v29, v130, v131
    v_cvt_pk_bf16_f32 v30, v132, v133
    v_cvt_pk_bf16_f32 v31, v134, v135
    v_cvt_pk_bf16_f32 v32, v120, v121
    v_cvt_pk_bf16_f32 v33, v122, v123
    v_cvt_pk_bf16_f32 v34, v124, v125
    v_cvt_pk_bf16_f32 v35, v126, v127
    v_cvt_pk_bf16_f32 v36, v136, v137
    v_cvt_pk_bf16_f32 v37, v138, v139
    v_cvt_pk_bf16_f32 v38, v140, v141
    v_cvt_pk_bf16_f32 v39, v142, v143
    v_cvt_pk_bf16_f32 v40, v144, v145
    v_cvt_pk_bf16_f32 v41, v146, v147
    v_cvt_pk_bf16_f32 v42, v148, v149
    v_cvt_pk_bf16_f32 v43, v150, v151
    v_cvt_pk_bf16_f32 v44, v160, v161
    v_cvt_pk_bf16_f32 v45, v162, v163
    v_cvt_pk_bf16_f32 v46, v164, v165
    v_cvt_pk_bf16_f32 v47, v166, v167
    v_cvt_pk_bf16_f32 v48, v152, v153
    v_cvt_pk_bf16_f32 v49, v154, v155
    v_cvt_pk_bf16_f32 v50, v156, v157
    v_cvt_pk_bf16_f32 v51, v158, v159
    v_cvt_pk_bf16_f32 v52, v168, v169
    v_cvt_pk_bf16_f32 v53, v170, v171
    v_cvt_pk_bf16_f32 v54, v172, v173
    v_cvt_pk_bf16_f32 v55, v174, v175
    v_mov_b32 v176, 0x3f803f80
    v_cndmask_b32 v44, v44, v176, s[58:59]
    v_cndmask_b32 v45, v45, v176, s[58:59]
    v_cndmask_b32 v46, v46, v176, s[58:59]
    v_cndmask_b32 v47, v47, v176, s[58:59]
    v_cndmask_b32 v52, v52, v176, s[58:59]
    v_cndmask_b32 v53, v53, v176, s[58:59]
    v_cndmask_b32 v54, v54, v176, s[58:59]
    v_cndmask_b32 v55, v55, v176, s[58:59]
    s_cmp_eq_u32 s5, 0
    s_nop 0
    s_cbranch_scc1 L_B_s0
    v_mfma_f32_16x16x32_bf16 v[56:59], v[24:27], v[40:43], 0
    v_mfma_f32_16x16x32_bf16 v[60:63], v[24:27], v[44:47], 0
    v_mfma_f32_16x16x32_bf16 v[56:59], v[32:35], v[48:51], v[56:59]
    v_mfma_f32_16x16x32_bf16 v[60:63], v[32:35], v[52:55], v[60:63]
    v_mfma_f32_16x16x32_bf16 v[64:67], v[28:31], v[40:43], 0
    v_mfma_f32_16x16x32_bf16 v[68:71], v[28:31], v[44:47], 0
    v_mfma_f32_16x16x32_bf16 v[64:67], v[36:39], v[48:51], v[64:67]
    v_mfma_f32_16x16x32_bf16 v[68:71], v[36:39], v[52:55], v[68:71]
    s_branch L_B_s1
L_B_s0:
    v_mfma_f32_16x16x32_bf16 v[56:59], v[28:31], v[40:43], 0
    v_mfma_f32_16x16x32_bf16 v[60:63], v[28:31], v[44:47], 0
    v_mfma_f32_16x16x32_bf16 v[56:59], v[36:39], v[48:51], v[56:59]
    v_mfma_f32_16x16x32_bf16 v[60:63], v[36:39], v[52:55], v[60:63]
    v_mfma_f32_16x16x32_bf16 v[64:67], v[24:27], v[40:43], 0
    v_mfma_f32_16x16x32_bf16 v[68:71], v[24:27], v[44:47], 0
    v_mfma_f32_16x16x32_bf16 v[64:67], v[32:35], v[48:51], v[64:67]
    v_mfma_f32_16x16x32_bf16 v[68:71], v[32:35], v[52:55], v[68:71]
L_B_s1:
    s_lshl_b32 s45, s39, 10
    s_add_u32 s45, s45, s81
    s_nop 1
    ds_write_b128 v217, v[56:59]
    ds_write_b128 v217, v[60:63] offset:1024
    s_waitcnt lgkmcnt(0)
    s_barrier
    ds_read_b128 v[72:75], v218
    ds_read_b128 v[76:79], v218 offset:1024
    s_waitcnt lgkmcnt(0)
    v_pk_add_f32 v[64:65], v[64:65], v[72:73]
    v_pk_add_f32 v[66:67], v[66:67], v[74:75]
    v_pk_add_f32 v[68:69], v[68:69], v[76:77]
    v_pk_add_f32 v[70:71], v[70:71], v[78:79]
    v_cvt_pk_bf16_f32 v80, v64, v65
    v_cvt_pk_bf16_f32 v81, v66, v67
    v_cvt_pk_bf16_f32 v82, v68, v69
    v_cvt_pk_bf16_f32 v83, v70, v71
    buffer_store_dwordx4 v[80:83], v236, s[16:19], s45 offen sc1
    s_mov_b64 exec, 1
    ds_add_u32 v216, v250 offset:24
    s_mov_b64 exec, -1
    s_waitcnt vmcnt(0)
    v_mov_b32 v176, s42
    v_mov_b32 v177, s43
    s_mov_b64 exec, 1
    buffer_store_dwordx2 v[176:177], off, s[16:19], s82 sc1
    s_mov_b64 exec, -1
    buffer_load_dwordx2 v[178:179], v237, s[16:19], s83 offen sc1
    s_mov_b32 s64, 0
L_poll_70:
    s_waitcnt vmcnt(0)
    v_cmp_ne_u64 vcc, s[42:43], v[178:179]
    s_add_u32 s64, s64, 1
    s_cbranch_vccz L_polld_71
    s_cmp_gt_u32 s64, 0x40000
    s_cbranch_scc1 L_polld_71
    buffer_load_dwordx2 v[178:179], v237, s[16:19], s83 offen sc1
    s_branch L_poll_70
L_polld_71:
    buffer_load_dwordx4 v[112:115], v236, s[16:19], s81 offen offset:0 sc1
    buffer_load_dwordx4 v[116:119], v236, s[16:19], s81 offen offset:1024 sc1
    buffer_load_dwordx4 v[120:123], v236, s[16:19], s81 offen offset:2048 sc1
    buffer_load_dwordx4 v[124:127], v236, s[16:19], s81 offen offset:3072 sc1
    s_add_u32 s45, s81, 4096
    buffer_load_dwordx4 v[128:131], v236, s[16:19], s45 offen offset:0 sc1
    buffer_load_dwordx4 v[132:135], v236, s[16:19], s45 offen offset:1024 sc1
    buffer_load_dwordx4 v[136:139], v236, s[16:19], s45 offen offset:2048 sc1
    buffer_load_dwordx4 v[140:143], v236, s[16:19], s45 offen offset:3072 sc1
    s_add_u32 s45, s81, 8192
    buffer_load_dwordx4 v[144:147], v236, s[16:19], s45 offen offset:0 sc1
    buffer_load_dwordx4 v[148:151], v236, s[16:19], s45 offen offset:1024 sc1
    buffer_load_dwordx4 v[152:155], v236, s[16:19], s45 offen offset:2048 sc1
    buffer_load_dwordx4 v[156:159], v236, s[16:19], s45 offen offset:3072 sc1
    s_add_u32 s45, s81, 12288
    buffer_load_dwordx4 v[160:163], v236, s[16:19], s45 offen offset:0 sc1
    buffer_load_dwordx4 v[164:167], v236, s[16:19], s45 offen offset:1024 sc1
    buffer_load_dwordx4 v[168:171], v236, s[16:19], s45 offen offset:2048 sc1
    buffer_load_dwordx4 v[172:175], v236, s[16:19], s45 offen offset:3072 sc1
    s_waitcnt vmcnt(15)
    v_mfma_f32_16x16x32_bf16 v[24:27], v[224:227], v[112:115], 0
    v_mfma_f32_16x16x32_bf16 v[28:31], v[228:231], v[112:115], 0
    s_waitcnt vmcnt(14)
    v_mfma_f32_16x16x32_bf16 v[24:27], v[224:227], v[116:119], v[24:27]
    v_mfma_f32_16x16x32_bf16 v[28:31], v[228:231], v[116:119], v[28:31]
    s_waitcnt vmcnt(13)
    v_mfma_f32_16x16x32_bf16 v[24:27], v[224:227], v[120:123], v[24:27]
    v_mfma_f32_16x16x32_bf16 v[28:31], v[228:231], v[120:123], v[28:31]
    s_waitcnt vmcnt(12)
    v_mfma_f32_16x16x32_bf16 v[24:27], v[224:227], v[124:127], v[24:27]
    v_mfma_f32_16x16x32_bf16 v[28:31], v[228:231], v[124:127], v[28:31]
    s_waitcnt vmcnt(11)
    v_mfma_f32_16x16x32_bf16 v[24:27], v[224:227], v[128:131], v[24:27]
    v_mfma_f32_16x16x32_bf16 v[28:31], v[228:231], v[128:131], v[28:31]
    s_waitcnt vmcnt(10)
    v_mfma_f32_16x16x32_bf16 v[24:27], v[224:227], v[132:135], v[24:27]
    v_mfma_f32_16x16x32_bf16 v[28:31], v[228:231], v[132:135], v[28:31]
    s_waitcnt vmcnt(9)
    v_mfma_f32_16x16x32_bf16 v[24:27], v[224:227], v[136:139], v[24:27]
    v_mfma_f32_16x16x32_bf16 v[28:31], v[228:231], v[136:139], v[28:31]
    s_waitcnt vmcnt(8)
    v_mfma_f32_16x16x32_bf16 v[24:27], v[224:227], v[140:143], v[24:27]
    v_mfma_f32_16x16x32_bf16 v[28:31], v[228:231], v[140:143], v[28:31]
    s_waitcnt vmcnt(7)
    v_mfma_f32_16x16x32_bf16 v[24:27], v[224:227], v[144:147], v[24:27]
    v_mfma_f32_16x16x32_bf16 v[28:31], v[228:231], v[144:147], v[28:31]
    s_waitcnt vmcnt(6)
    v_mfma_f32_16x16x32_bf16 v[24:27], v[224:227], v[148:151], v[24:27]
    v_mfma_f32_16x16x32_bf16 v[28:31], v[228:231], v[148:151], v[28:31]
    s_waitcnt vmcnt(5)
    v_mfma_f32_16x16x32_bf16 v[24:27], v[224:227], v[152:155], v[24:27]
    v_mfma_f32_16x16x32_bf16 v[28:31], v[228:231], v[152:155], v[28:31]
    s_waitcnt vmcnt(4)
    v_mfma_f32_16x16x32_bf16 v[24:27], v[224:227], v[156:159], v[24:27]
    v_mfma_f32_16x16x32_bf16 v[28:31], v[228:231], v[156:159], v[28:31]
    s_waitcnt vmcnt(3)
    v_mfma_f32_16x16x32_bf16 v[24:27], v[224:227], v[160:163], v[24:27]
    v_mfma_f32_16x16x32_bf16 v[28:31], v[228:231], v[160:163], v[28:31]
    s_waitcnt vmcnt(2)
    v_mfma_f32_16x16x32_bf16 v[24:27], v[224:227], v[164:167], v[24:27]
    v_mfma_f32_16x16x32_bf16 v[28:31], v[228:231], v[164:167], v[28:31]
    s_waitcnt vmcnt(1)
    v_mfma_f32_16x16x32_bf16 v[24:27], v[224:227], v[168:171], v[24:27]
    v_mfma_f32_16x16x32_bf16 v[28:31], v[228:231], v[168:171], v[28:31]
    s_waitcnt vmcnt(0)
    v_mfma_f32_16x16x32_bf16 v[24:27], v[224:227], v[172:175], v[24:27]
    v_mfma_f32_16x16x32_bf16 v[28:31], v[228:231], v[172:175], v[28:31]
    s_nop 6
    v_cvt_pk_bf16_f32 v32, v24, v25
    v_cvt_pk_bf16_f32 v33, v26, v27
    v_cvt_pk_bf16_f32 v34, v28, v29
    v_cvt_pk_bf16_f32 v35, v30, v31
    ds_write_b64 v220, v[32:33]
    ds_write_b64 v220, v[34:35] offset:1024
    s_waitcnt lgkmcnt(0)
    s_mov_b64 exec, 1
    ds_add_u32 v223, v250 offset:0
    s_mov_b64 exec, -1
    v_subrev_u32 v6, 149504, v217
    s_mov_b32 s64, 0
L_spin_72:
    ds_read_b32 v4, v223 offset:0
    ds_read_b32 v5, v219 offset:0
    s_add_u32 s64, s64, 1
    s_waitcnt lgkmcnt(0)
    v_add_u32 v4, v4, v5
    s_cmp_gt_u32 s64, 0x200000
    v_readfirstlane_b32 s44, v4
    s_cbranch_scc1 L_spind_73
    s_cmp_lg_u32 s44, 3
    s_cbranch_scc1 L_spin_72
L_spind_73:
    ds_read_b128 v[64:67], v6
    ds_read_b128 v[68:71], v6 offset:1024
    ds_read_b128 v[32:35], v222 offset:1216
    ds_read_b128 v[24:27], v221
    ds_read_b128 v[28:31], v221 offset:1024
    s_waitcnt lgkmcnt(2)
    v_mfma_f32_16x16x32_bf16 v[120:123], v[32:35], v[64:67], 0
    v_mfma_f32_16x16x32_bf16 v[132:135], v[32:35], v[68:71], 0
    s_waitcnt lgkmcnt(1)
    v_mfma_f32_16x16x32_bf16 v[112:115], v[24:27], v[64:67], 0
    v_mfma_f32_16x16x32_bf16 v[124:127], v[24:27], v[68:71], 0
    s_waitcnt lgkmcnt(0)
    v_mfma_f32_16x16x32_bf16 v[116:119], v[28:31], v[64:67], 0
    v_mfma_f32_16x16x32_bf16 v[128:131], v[28:31], v[68:71], 0
    s_nop 1
    v_add_f32 v120, s70, v120
    v_add_f32 v132, s70, v132
    v_rcp_f32 v120, v120
    v_rcp_f32 v132, v132
    s_add_u32 s44, s76, 16384
    s_nop 0
    v_mul_f32 v112, v112, v120
    v_mul_f32 v113, v113, v120
    v_mul_f32 v114, v114, v120
    v_mul_f32 v115, v115, v120
    v_mul_f32 v116, v116, v120
    v_mul_f32 v117, v117, v120
    v_mul_f32 v118, v118, v120
    v_mul_f32 v119, v119, v120
    v_cvt_pk_bf16_f32 v136, v112, v113
    v_cvt_pk_bf16_f32 v137, v114, v115
    v_cvt_pk_bf16_f32 v138, v116, v117
    v_cvt_pk_bf16_f32 v139, v118, v119
    v_cndmask_b32 v138, 0, v138, s[54:55]
    v_cndmask_b32 v139, 0, v139, s[54:55]
    buffer_store_dwordx4 v[136:139], v236, s[16:19], s76 offen sc1
    v_mul_f32 v124, v124, v132
    v_mul_f32 v125, v125, v132
    v_mul_f32 v126, v126, v132
    v_mul_f32 v127, v127, v132
    v_mul_f32 v128, v128, v132
    v_mul_f32 v129, v129, v132
    v_mul_f32 v130, v130, v132
    v_mul_f32 v131, v131, v132
    v_cvt_pk_bf16_f32 v140, v124, v125
    v_cvt_pk_bf16_f32 v141, v126, v127
    v_cvt_pk_bf16_f32 v142, v128, v129
    v_cvt_pk_bf16_f32 v143, v130, v131
    v_cndmask_b32 v142, 0, v142, s[54:55]
    v_cndmask_b32 v143, 0, v143, s[54:55]
    buffer_store_dwordx4 v[140:143], v236, s[16:19], s44 offen sc1
    s_waitcnt vmcnt(0)
    v_mov_b32 v24, s42
    v_mov_b32 v25, s43
    s_mov_b64 exec, 1
    buffer_store_dwordx2 v[24:25], off, s[16:19], s77 sc1
    s_mov_b64 exec, -1
    s_endpgm
L_phase2:
    v_mov_b32 v228, 0
    v_mov_b32 v229, 0
    v_lshlrev_b32 v230, 3, v1
    v_add_u32 v230, 114688, v230
    ds_write_b64 v230, v[228:229]
    v_add_u32 v250, 57344, v240
    v_add_u32 v251, 57344, v241
    v_add_u32 v252, 57344, v242
    v_add_u32 v253, 57344, v243
    s_waitcnt vmcnt(0) lgkmcnt(0)
    s_barrier
    buffer_load_dwordx2 v[232:233], v237, s[16:19], s78 offen sc1
    ds_read_b64_tr_b16 v[100:101], v240 offset:0
    ds_read_b64_tr_b16 v[102:103], v240 offset:2048
    ds_read_b64_tr_b16 v[104:105], v241 offset:0
    ds_read_b64_tr_b16 v[106:107], v241 offset:2048
    ds_read_b64_tr_b16 v[108:109], v242 offset:0
    ds_read_b64_tr_b16 v[110:111], v242 offset:2048
    ds_read_b64_tr_b16 v[112:113], v243 offset:0
    ds_read_b64_tr_b16 v[114:115], v243 offset:2048
    ds_read_b64_tr_b16 v[116:117], v242 offset:3584
    ds_read_b64_tr_b16 v[118:119], v242 offset:5632
    ds_read_b64_tr_b16 v[120:121], v243 offset:3584
    ds_read_b64_tr_b16 v[122:123], v243 offset:5632
    ds_read_b64_tr_b16 v[124:125], v240 offset:3584
    ds_read_b64_tr_b16 v[126:127], v240 offset:5632
    ds_read_b64_tr_b16 v[128:129], v241 offset:3584
    ds_read_b64_tr_b16 v[130:131], v241 offset:5632
    ds_read_b64_tr_b16 v[132:133], v240 offset:7168
    ds_read_b64_tr_b16 v[134:135], v240 offset:9216
    ds_read_b64_tr_b16 v[136:137], v241 offset:7168
    ds_read_b64_tr_b16 v[138:139], v241 offset:9216
    ds_read_b64_tr_b16 v[140:141], v242 offset:7168
    ds_read_b64_tr_b16 v[142:143], v242 offset:9216
    ds_read_b64_tr_b16 v[144:145], v243 offset:7168
    ds_read_b64_tr_b16 v[146:147], v243 offset:9216
    ds_read_b64_tr_b16 v[148:149], v242 offset:10752
    ds_read_b64_tr_b16 v[150:151], v242 offset:12800
    ds_read_b64_tr_b16 v[152:153], v243 offset:10752
    ds_read_b64_tr_b16 v[154:155], v243 offset:12800
    ds_read_b64_tr_b16 v[156:157], v240 offset:10752
    ds_read_b64_tr_b16 v[158:159], v240 offset:12800
    ds_read_b64_tr_b16 v[160:161], v241 offset:10752
    ds_read_b64_tr_b16 v[162:163], v241 offset:12800
    ds_read_b64_tr_b16 v[164:165], v240 offset:14336
    ds_read_b64_tr_b16 v[166:167], v240 offset:16384
    ds_read_b64_tr_b16 v[168:169], v241 offset:14336
    ds_read_b64_tr_b16 v[170:171], v241 offset:16384
    ds_read_b64_tr_b16 v[172:173], v242 offset:14336
    ds_read_b64_tr_b16 v[174:175], v242 offset:16384
    ds_read_b64_tr_b16 v[176:177], v243 offset:14336
    ds_read_b64_tr_b16 v[178:179], v243 offset:16384
    ds_read_b64_tr_b16 v[180:181], v242 offset:17920
    ds_read_b64_tr_b16 v[182:183], v242 offset:19968
    ds_read_b64_tr_b16 v[184:185], v243 offset:17920
    ds_read_b64_tr_b16 v[186:187], v243 offset:19968
    ds_read_b64_tr_b16 v[188:189], v240 offset:17920
    ds_read_b64_tr_b16 v[190:191], v240 offset:19968
    ds_read_b64_tr_b16 v[192:193], v241 offset:17920
    ds_read_b64_tr_b16 v[194:195], v241 offset:19968
    ds_read_b64_tr_b16 v[196:197], v240 offset:21504
    ds_read_b64_tr_b16 v[198:199], v240 offset:23552
    ds_read_b64_tr_b16 v[200:201], v241 offset:21504
    ds_read_b64_tr_b16 v[202:203], v241 offset:23552
    ds_read_b64_tr_b16 v[204:205], v242 offset:21504
    ds_read_b64_tr_b16 v[206:207], v242 offset:23552
    ds_read_b64_tr_b16 v[208:209], v243 offset:21504
    ds_read_b64_tr_b16 v[210:211], v243 offset:23552
    ds_read_b64_tr_b16 v[212:213], v242 offset:25088
    ds_read_b64_tr_b16 v[214:215], v242 offset:27136
    ds_read_b64_tr_b16 v[216:217], v243 offset:25088
    ds_read_b64_tr_b16 v[218:219], v243 offset:27136
    ds_read_b64_tr_b16 v[220:221], v240 offset:25088
    ds_read_b64_tr_b16 v[222:223], v240 offset:27136
    ds_read_b64_tr_b16 v[224:225], v241 offset:25088
    ds_read_b64_tr_b16 v[226:227], v241 offset:27136
    s_mov_b32 s64, 0
L_poll_74:
    s_waitcnt vmcnt(0)
    v_cmp_ne_u64 vcc, s[42:43], v[232:233]
    s_add_u32 s64, s64, 1
    s_cbranch_vccz L_polld_75
    s_cmp_gt_u32 s64, 0x40000
    s_cbranch_scc1 L_polld_75
    buffer_load_dwordx2 v[232:233], v237, s[16:19], s78 offen sc1
    s_branch L_poll_74
L_polld_75:
    s_add_u32 s45, s79, 0
    buffer_load_dwordx4 v[36:39], v236, s[16:19], s45 offen offset:0 sc1
    buffer_load_dwordx4 v[40:43], v236, s[16:19], s45 offen offset:1024 sc1
    buffer_load_dwordx4 v[44:47], v236, s[16:19], s45 offen offset:2048 sc1
    buffer_load_dwordx4 v[48:51], v236, s[16:19], s45 offen offset:3072 sc1
    s_add_u32 s45, s79, 4096
    buffer_load_dwordx4 v[52:55], v236, s[16:19], s45 offen offset:0 sc1
    buffer_load_dwordx4 v[56:59], v236, s[16:19], s45 offen offset:1024 sc1
    buffer_load_dwordx4 v[60:63], v236, s[16:19], s45 offen offset:2048 sc1
    buffer_load_dwordx4 v[64:67], v236, s[16:19], s45 offen offset:3072 sc1
    s_add_u32 s45, s79, 8192
    buffer_load_dwordx4 v[68:71], v236, s[16:19], s45 offen offset:0 sc1
    buffer_load_dwordx4 v[72:75], v236, s[16:19], s45 offen offset:1024 sc1
    buffer_load_dwordx4 v[76:79], v236, s[16:19], s45 offen offset:2048 sc1
    buffer_load_dwordx4 v[80:83], v236, s[16:19], s45 offen offset:3072 sc1
    s_add_u32 s45, s79, 12288
    buffer_load_dwordx4 v[84:87], v236, s[16:19], s45 offen offset:0 sc1
    buffer_load_dwordx4 v[88:91], v236, s[16:19], s45 offen offset:1024 sc1
    buffer_load_dwordx4 v[92:95], v236, s[16:19], s45 offen offset:2048 sc1
    buffer_load_dwordx4 v[96:99], v236, s[16:19], s45 offen offset:3072 sc1
    s_add_u32 s78, s78, 2048
    s_add_u32 s79, s79, 131072
    s_waitcnt vmcnt(15)
    s_waitcnt lgkmcnt(15)
    v_mfma_f32_16x16x32_bf16 v[4:7], v[100:103], v[36:39], 0
    ds_read_b64_tr_b16 v[100:101], v240 offset:28672
    ds_read_b64_tr_b16 v[102:103], v240 offset:30720
    v_mfma_f32_16x16x32_bf16 v[8:11], v[104:107], v[36:39], 0
    ds_read_b64_tr_b16 v[104:105], v241 offset:28672
    ds_read_b64_tr_b16 v[106:107], v241 offset:30720
    v_mfma_f32_16x16x32_bf16 v[12:15], v[108:111], v[36:39], 0
    ds_read_b64_tr_b16 v[108:109], v242 offset:28672
    ds_read_b64_tr_b16 v[110:111], v242 offset:30720
    v_mfma_f32_16x16x32_bf16 v[16:19], v[112:115], v[36:39], 0
    ds_read_b64_tr_b16 v[112:113], v243 offset:28672
    ds_read_b64_tr_b16 v[114:115], v243 offset:30720
    s_waitcnt vmcnt(14)
    v_mfma_f32_16x16x32_bf16 v[4:7], v[116:119], v[40:43], v[4:7]
    ds_read_b64_tr_b16 v[116:117], v242 offset:32256
    ds_read_b64_tr_b16 v[118:119], v242 offset:34304
    v_mfma_f32_16x16x32_bf16 v[8:11], v[120:123], v[40:43], v[8:11]
    ds_read_b64_tr_b16 v[120:121], v243 offset:32256
    ds_read_b64_tr_b16 v[122:123], v243 offset:34304
    v_mfma_f32_16x16x32_bf16 v[12:15], v[124:127], v[40:43], v[12:15]
    ds_read_b64_tr_b16 v[124:125], v240 offset:32256
    ds_read_b64_tr_b16 v[126:127], v240 offset:34304
    v_mfma_f32_16x16x32_bf16 v[16:19], v[128:131], v[40:43], v[16:19]
    ds_read_b64_tr_b16 v[128:129], v241 offset:32256
    ds_read_b64_tr_b16 v[130:131], v241 offset:34304
    s_waitcnt vmcnt(13)
    v_mfma_f32_16x16x32_bf16 v[4:7], v[132:135], v[44:47], v[4:7]
    ds_read_b64_tr_b16 v[132:133], v240 offset:35840
    ds_read_b64_tr_b16 v[134:135], v240 offset:37888
    v_mfma_f32_16x16x32_bf16 v[8:11], v[136:139], v[44:47], v[8:11]
    ds_read_b64_tr_b16 v[136:137], v241 offset:35840
    ds_read_b64_tr_b16 v[138:139], v241 offset:37888
    v_mfma_f32_16x16x32_bf16 v[12:15], v[140:143], v[44:47], v[12:15]
    ds_read_b64_tr_b16 v[140:141], v242 offset:35840
    ds_read_b64_tr_b16 v[142:143], v242 offset:37888
    v_mfma_f32_16x16x32_bf16 v[16:19], v[144:147], v[44:47], v[16:19]
    ds_read_b64_tr_b16 v[144:145], v243 offset:35840
    ds_read_b64_tr_b16 v[146:147], v243 offset:37888
    s_waitcnt vmcnt(12)
    v_mfma_f32_16x16x32_bf16 v[4:7], v[148:151], v[48:51], v[4:7]
    ds_read_b64_tr_b16 v[148:149], v242 offset:39424
    ds_read_b64_tr_b16 v[150:151], v242 offset:41472
    v_mfma_f32_16x16x32_bf16 v[8:11], v[152:155], v[48:51], v[8:11]
    ds_read_b64_tr_b16 v[152:153], v243 offset:39424
    ds_read_b64_tr_b16 v[154:155], v243 offset:41472
    v_mfma_f32_16x16x32_bf16 v[12:15], v[156:159], v[48:51], v[12:15]
    ds_read_b64_tr_b16 v[156:157], v240 offset:39424
    ds_read_b64_tr_b16 v[158:159], v240 offset:41472
    v_mfma_f32_16x16x32_bf16 v[16:19], v[160:163], v[48:51], v[16:19]
    ds_read_b64_tr_b16 v[160:161], v241 offset:39424
    ds_read_b64_tr_b16 v[162:163], v241 offset:41472
    s_waitcnt vmcnt(11)
    v_mfma_f32_16x16x32_bf16 v[4:7], v[164:167], v[52:55], v[4:7]
    ds_read_b64_tr_b16 v[164:165], v240 offset:43008
    ds_read_b64_tr_b16 v[166:167], v240 offset:45056
    v_mfma_f32_16x16x32_bf16 v[8:11], v[168:171], v[52:55], v[8:11]
    ds_read_b64_tr_b16 v[168:169], v241 offset:43008
    ds_read_b64_tr_b16 v[170:171], v241 offset:45056
    v_mfma_f32_16x16x32_bf16 v[12:15], v[172:175], v[52:55], v[12:15]
    ds_read_b64_tr_b16 v[172:173], v242 offset:43008
    ds_read_b64_tr_b16 v[174:175], v242 offset:45056
    v_mfma_f32_16x16x32_bf16 v[16:19], v[176:179], v[52:55], v[16:19]
    ds_read_b64_tr_b16 v[176:177], v243 offset:43008
    ds_read_b64_tr_b16 v[178:179], v243 offset:45056
    s_waitcnt vmcnt(10)
    v_mfma_f32_16x16x32_bf16 v[4:7], v[180:183], v[56:59], v[4:7]
    ds_read_b64_tr_b16 v[180:181], v242 offset:46592
    ds_read_b64_tr_b16 v[182:183], v242 offset:48640
    v_mfma_f32_16x16x32_bf16 v[8:11], v[184:187], v[56:59], v[8:11]
    ds_read_b64_tr_b16 v[184:185], v243 offset:46592
    ds_read_b64_tr_b16 v[186:187], v243 offset:48640
    v_mfma_f32_16x16x32_bf16 v[12:15], v[188:191], v[56:59], v[12:15]
    ds_read_b64_tr_b16 v[188:189], v240 offset:46592
    ds_read_b64_tr_b16 v[190:191], v240 offset:48640
    v_mfma_f32_16x16x32_bf16 v[16:19], v[192:195], v[56:59], v[16:19]
    ds_read_b64_tr_b16 v[192:193], v241 offset:46592
    ds_read_b64_tr_b16 v[194:195], v241 offset:48640
    s_waitcnt vmcnt(9)
    s_waitcnt lgkmcnt(15)
    v_mfma_f32_16x16x32_bf16 v[4:7], v[196:199], v[60:63], v[4:7]
    ds_read_b64_tr_b16 v[196:197], v240 offset:50176
    ds_read_b64_tr_b16 v[198:199], v240 offset:52224
    v_mfma_f32_16x16x32_bf16 v[8:11], v[200:203], v[60:63], v[8:11]
    ds_read_b64_tr_b16 v[200:201], v241 offset:50176
    ds_read_b64_tr_b16 v[202:203], v241 offset:52224
    v_mfma_f32_16x16x32_bf16 v[12:15], v[204:207], v[60:63], v[12:15]
    ds_read_b64_tr_b16 v[204:205], v242 offset:50176
    ds_read_b64_tr_b16 v[206:207], v242 offset:52224
    v_mfma_f32_16x16x32_bf16 v[16:19], v[208:211], v[60:63], v[16:19]
    ds_read_b64_tr_b16 v[208:209], v243 offset:50176
    ds_read_b64_tr_b16 v[210:211], v243 offset:52224
    s_waitcnt vmcnt(8)
    v_mfma_f32_16x16x32_bf16 v[4:7], v[212:215], v[64:67], v[4:7]
    ds_read_b64_tr_b16 v[212:213], v242 offset:53760
    ds_read_b64_tr_b16 v[214:215], v242 offset:55808
    v_mfma_f32_16x16x32_bf16 v[8:11], v[216:219], v[64:67], v[8:11]
    ds_read_b64_tr_b16 v[216:217], v243 offset:53760
    ds_read_b64_tr_b16 v[218:219], v243 offset:55808
    v_mfma_f32_16x16x32_bf16 v[12:15], v[220:223], v[64:67], v[12:15]
    ds_read_b64_tr_b16 v[220:221], v240 offset:53760
    ds_read_b64_tr_b16 v[222:223], v240 offset:55808
    v_mfma_f32_16x16x32_bf16 v[16:19], v[224:227], v[64:67], v[16:19]
    ds_read_b64_tr_b16 v[224:225], v241 offset:53760
    ds_read_b64_tr_b16 v[226:227], v241 offset:55808
    s_waitcnt vmcnt(7)
    v_mfma_f32_16x16x32_bf16 v[4:7], v[100:103], v[68:71], v[4:7]
    ds_read_b64_tr_b16 v[100:101], v250 offset:0
    ds_read_b64_tr_b16 v[102:103], v250 offset:2048
    v_mfma_f32_16x16x32_bf16 v[8:11], v[104:107], v[68:71], v[8:11]
    ds_read_b64_tr_b16 v[104:105], v251 offset:0
    ds_read_b64_tr_b16 v[106:107], v251 offset:2048
    v_mfma_f32_16x16x32_bf16 v[12:15], v[108:111], v[68:71], v[12:15]
    ds_read_b64_tr_b16 v[108:109], v252 offset:0
    ds_read_b64_tr_b16 v[110:111], v252 offset:2048
    v_mfma_f32_16x16x32_bf16 v[16:19], v[112:115], v[68:71], v[16:19]
    ds_read_b64_tr_b16 v[112:113], v253 offset:0
    ds_read_b64_tr_b16 v[114:115], v253 offset:2048
    buffer_load_dwordx2 v[232:233], v237, s[16:19], s78 offen sc1
    s_waitcnt vmcnt(7)
    v_mfma_f32_16x16x32_bf16 v[4:7], v[116:119], v[72:75], v[4:7]
    ds_read_b64_tr_b16 v[116:117], v252 offset:3584
    ds_read_b64_tr_b16 v[118:119], v252 offset:5632
    v_mfma_f32_16x16x32_bf16 v[8:11], v[120:123], v[72:75], v[8:11]
    ds_read_b64_tr_b16 v[120:121], v253 offset:3584
    ds_read_b64_tr_b16 v[122:123], v253 offset:5632
    v_mfma_f32_16x16x32_bf16 v[12:15], v[124:127], v[72:75], v[12:15]
    ds_read_b64_tr_b16 v[124:125], v250 offset:3584
    ds_read_b64_tr_b16 v[126:127], v250 offset:5632
    v_mfma_f32_16x16x32_bf16 v[16:19], v[128:131], v[72:75], v[16:19]
    ds_read_b64_tr_b16 v[128:129], v251 offset:3584
    ds_read_b64_tr_b16 v[130:131], v251 offset:5632
    s_waitcnt vmcnt(6)
    v_mfma_f32_16x16x32_bf16 v[4:7], v[132:135], v[76:79], v[4:7]
    ds_read_b64_tr_b16 v[132:133], v250 offset:7168
    ds_read_b64_tr_b16 v[134:135], v250 offset:9216
    v_mfma_f32_16x16x32_bf16 v[8:11], v[136:139], v[76:79], v[8:11]
    ds_read_b64_tr_b16 v[136:137], v251 offset:7168
    ds_read_b64_tr_b16 v[138:139], v251 offset:9216
    v_mfma_f32_16x16x32_bf16 v[12:15], v[140:143], v[76:79], v[12:15]
    ds_read_b64_tr_b16 v[140:141], v252 offset:7168
    ds_read_b64_tr_b16 v[142:143], v252 offset:9216
    v_mfma_f32_16x16x32_bf16 v[16:19], v[144:147], v[76:79], v[16:19]
    ds_read_b64_tr_b16 v[144:145], v253 offset:7168
    ds_read_b64_tr_b16 v[146:147], v253 offset:9216
    s_waitcnt vmcnt(5)
    v_mfma_f32_16x16x32_bf16 v[4:7], v[148:151], v[80:83], v[4:7]
    ds_read_b64_tr_b16 v[148:149], v252 offset:10752
    ds_read_b64_tr_b16 v[150:151], v252 offset:12800
    v_mfma_f32_16x16x32_bf16 v[8:11], v[152:155], v[80:83], v[8:11]
    ds_read_b64_tr_b16 v[152:153], v253 offset:10752
    ds_read_b64_tr_b16 v[154:155], v253 offset:12800
    v_mfma_f32_16x16x32_bf16 v[12:15], v[156:159], v[80:83], v[12:15]
    ds_read_b64_tr_b16 v[156:157], v250 offset:10752
    ds_read_b64_tr_b16 v[158:159], v250 offset:12800
    v_mfma_f32_16x16x32_bf16 v[16:19], v[160:163], v[80:83], v[16:19]
    ds_read_b64_tr_b16 v[160:161], v251 offset:10752
    ds_read_b64_tr_b16 v[162:163], v251 offset:12800
    s_waitcnt vmcnt(0)
    v_cmp_ne_u64 vcc, s[42:43], v[232:233]
    s_mov_b32 s85, 0
    s_cbranch_vccnz L_p2_late
    s_add_u32 s45, s79, 0
    buffer_load_dwordx4 v[36:39], v236, s[16:19], s45 offen offset:0 sc1
    buffer_load_dwordx4 v[40:43], v236, s[16:19], s45 offen offset:1024 sc1
    buffer_load_dwordx4 v[44:47], v236, s[16:19], s45 offen offset:2048 sc1
    buffer_load_dwordx4 v[48:51], v236, s[16:19], s45 offen offset:3072 sc1
    s_add_u32 s45, s79, 4096
    buffer_load_dwordx4 v[52:55], v236, s[16:19], s45 offen offset:0 sc1
    buffer_load_dwordx4 v[56:59], v236, s[16:19], s45 offen offset:1024 sc1
    buffer_load_dwordx4 v[60:63], v236, s[16:19], s45 offen offset:2048 sc1
    buffer_load_dwordx4 v[64:67], v236, s[16:19], s45 offen offset:3072 sc1
    s_add_u32 s45, s79, 8192
    buffer_load_dwordx4 v[68:71], v236, s[16:19], s45 offen offset:0 sc1
    buffer_load_dwordx4 v[72:75], v236, s[16:19], s45 offen offset:1024 sc1
    buffer_load_dwordx4 v[76:79], v236, s[16:19], s45 offen offset:2048 sc1
    buffer_load_dwordx4 v[80:83], v236, s[16:19], s45 offen offset:3072 sc1
    s_mov_b32 s85, 1
L_p2_late:
    s_waitcnt lgkmcnt(15)
    v_mfma_f32_16x16x32_bf16 v[4:7], v[164:167], v[84:87], v[4:7]
    ds_read_b64_tr_b16 v[164:165], v250 offset:14336
    ds_read_b64_tr_b16 v[166:167], v250 offset:16384
    v_mfma_f32_16x16x32_bf16 v[8:11], v[168:171], v[84:87], v[8:11]
    ds_read_b64_tr_b16 v[168:169], v251 offset:14336
    ds_read_b64_tr_b16 v[170:171], v251 offset:16384
    v_mfma_f32_16x16x32_bf16 v[12:15], v[172:175], v[84:87], v[12:15]
    ds_read_b64_tr_b16 v[172:173], v252 offset:14336
    ds_read_b64_tr_b16 v[174:175], v252 offset:16384
    v_mfma_f32_16x16x32_bf16 v[16:19], v[176:179], v[84:87], v[16:19]
    ds_read_b64_tr_b16 v[176:177], v253 offset:14336
    ds_read_b64_tr_b16 v[178:179], v253 offset:16384
    v_mfma_f32_16x16x32_bf16 v[4:7], v[180:183], v[88:91], v[4:7]
    ds_read_b64_tr_b16 v[180:181], v252 offset:17920
    ds_read_b64_tr_b16 v[182:183], v252 offset:19968
    v_mfma_f32_16x16x32_bf16 v[8:11], v[184:187], v[88:91], v[8:11]
    ds_read_b64_tr_b16 v[184:185], v253 offset:17920
    ds_read_b64_tr_b16 v[186:187], v253 offset:19968
    v_mfma_f32_16x16x32_bf16 v[12:15], v[188:191], v[88:91], v[12:15]
    ds_read_b64_tr_b16 v[188:189], v250 offset:17920
    ds_read_b64_tr_b16 v[190:191], v250 offset:19968
    v_mfma_f32_16x16x32_bf16 v[16:19], v[192:195], v[88:91], v[16:19]
    ds_read_b64_tr_b16 v[192:193], v251 offset:17920
    ds_read_b64_tr_b16 v[194:195], v251 offset:19968
    v_mfma_f32_16x16x32_bf16 v[4:7], v[196:199], v[92:95], v[4:7]
    ds_read_b64_tr_b16 v[196:197], v250 offset:21504
    ds_read_b64_tr_b16 v[198:199], v250 offset:23552
    v_mfma_f32_16x16x32_bf16 v[8:11], v[200:203], v[92:95], v[8:11]
    ds_read_b64_tr_b16 v[200:201], v251 offset:21504
    ds_read_b64_tr_b16 v[202:203], v251 offset:23552
    v_mfma_f32_16x16x32_bf16 v[12:15], v[204:207], v[92:95], v[12:15]
    ds_read_b64_tr_b16 v[204:205], v252 offset:21504
    ds_read_b64_tr_b16 v[206:207], v252 offset:23552
    v_mfma_f32_16x16x32_bf16 v[16:19], v[208:211], v[92:95], v[16:19]
    ds_read_b64_tr_b16 v[208:209], v253 offset:21504
    ds_read_b64_tr_b16 v[210:211], v253 offset:23552
    v_mfma_f32_16x16x32_bf16 v[4:7], v[212:215], v[96:99], v[4:7]
    ds_read_b64_tr_b16 v[212:213], v252 offset:25088
    ds_read_b64_tr_b16 v[214:215], v252 offset:27136
    v_mfma_f32_16x16x32_bf16 v[8:11], v[216:219], v[96:99], v[8:11]
    ds_read_b64_tr_b16 v[216:217], v253 offset:25088
    ds_read_b64_tr_b16 v[218:219], v253 offset:27136
    v_mfma_f32_16x16x32_bf16 v[12:15], v[220:223], v[96:99], v[12:15]
    ds_read_b64_tr_b16 v[220:221], v250 offset:25088
    ds_read_b64_tr_b16 v[222:223], v250 offset:27136
    v_mfma_f32_16x16x32_bf16 v[16:19], v[224:227], v[96:99], v[16:19]
    ds_read_b64_tr_b16 v[224:225], v251 offset:25088
    ds_read_b64_tr_b16 v[226:227], v251 offset:27136
    s_cmp_eq_u32 s85, 1
    s_cbranch_scc1 L_p2_haveB
    buffer_load_dwordx2 v[232:233], v237, s[16:19], s78 offen sc1
    s_mov_b32 s64, 0
L_poll_76:
    s_waitcnt vmcnt(0)
    v_cmp_ne_u64 vcc, s[42:43], v[232:233]
    s_add_u32 s64, s64, 1
    s_cbranch_vccz L_polld_77
    s_cmp_gt_u32 s64, 0x40000
    s_cbranch_scc1 L_polld_77
    buffer_load_dwordx2 v[232:233], v237, s[16:19], s78 offen sc1
    s_branch L_poll_76
L_polld_77:
    s_add_u32 s45, s79, 0
    buffer_load_dwordx4 v[36:39], v236, s[16:19], s45 offen offset:0 sc1
    buffer_load_dwordx4 v[40:43], v236, s[16:19], s45 offen offset:1024 sc1
    buffer_load_dwordx4 v[44:47], v236, s[16:19], s45 offen offset:2048 sc1
    buffer_load_dwordx4 v[48:51], v236, s[16:19], s45 offen offset:3072 sc1
    s_add_u32 s45, s79, 4096
    buffer_load_dwordx4 v[52:55], v236, s[16:19], s45 offen offset:0 sc1
    buffer_load_dwordx4 v[56:59], v236, s[16:19], s45 offen offset:1024 sc1
    buffer_load_dwordx4 v[60:63], v236, s[16:19], s45 offen offset:2048 sc1
    buffer_load_dwordx4 v[64:67], v236, s[16:19], s45 offen offset:3072 sc1
    s_add_u32 s45, s79, 8192
    buffer_load_dwordx4 v[68:71], v236, s[16:19], s45 offen offset:0 sc1
    buffer_load_dwordx4 v[72:75], v236, s[16:19], s45 offen offset:1024 sc1
    buffer_load_dwordx4 v[76:79], v236, s[16:19], s45 offen offset:2048 sc1
    buffer_load_dwordx4 v[80:83], v236, s[16:19], s45 offen offset:3072 sc1
L_p2_haveB:
    s_add_u32 s45, s79, 12288
    buffer_load_dwordx4 v[84:87], v236, s[16:19], s45 offen offset:0 sc1
    buffer_load_dwordx4 v[88:91], v236, s[16:19], s45 offen offset:1024 sc1
    buffer_load_dwordx4 v[92:95], v236, s[16:19], s45 offen offset:2048 sc1
    buffer_load_dwordx4 v[96:99], v236, s[16:19], s45 offen offset:3072 sc1
    buffer_load_dword v234, v244, s[16:19], s80 offen sc1
    s_waitcnt vmcnt(16)
    v_mfma_f32_16x16x32_bf16 v[20:23], v[100:103], v[36:39], 0
    ds_read_b64_tr_b16 v[100:101], v250 offset:28672
    ds_read_b64_tr_b16 v[102:103], v250 offset:30720
    v_mfma_f32_16x16x32_bf16 v[24:27], v[104:107], v[36:39], 0
    ds_read_b64_tr_b16 v[104:105], v251 offset:28672
    ds_read_b64_tr_b16 v[106:107], v251 offset:30720
    v_mfma_f32_16x16x32_bf16 v[28:31], v[108:111], v[36:39], 0
    ds_read_b64_tr_b16 v[108:109], v252 offset:28672
    ds_read_b64_tr_b16 v[110:111], v252 offset:30720
    v_mfma_f32_16x16x32_bf16 v[32:35], v[112:115], v[36:39], 0
    ds_read_b64_tr_b16 v[112:113], v253 offset:28672
    ds_read_b64_tr_b16 v[114:115], v253 offset:30720
    s_waitcnt vmcnt(15)
    v_mfma_f32_16x16x32_bf16 v[20:23], v[116:119], v[40:43], v[20:23]
    ds_read_b64_tr_b16 v[116:117], v252 offset:32256
    ds_read_b64_tr_b16 v[118:119], v252 offset:34304
    v_mfma_f32_16x16x32_bf16 v[24:27], v[120:123], v[40:43], v[24:27]
    ds_read_b64_tr_b16 v[120:121], v253 offset:32256
    ds_read_b64_tr_b16 v[122:123], v253 offset:34304
    v_mfma_f32_16x16x32_bf16 v[28:31], v[124:127], v[40:43], v[28:31]
    ds_read_b64_tr_b16 v[124:125], v250 offset:32256
    ds_read_b64_tr_b16 v[126:127], v250 offset:34304
    v_mfma_f32_16x16x32_bf16 v[32:35], v[128:131], v[40:43], v[32:35]
    ds_read_b64_tr_b16 v[128:129], v251 offset:32256
    ds_read_b64_tr_b16 v[130:131], v251 offset:34304
    s_waitcnt vmcnt(14)
    s_waitcnt lgkmcnt(15)
    v_mfma_f32_16x16x32_bf16 v[20:23], v[132:135], v[44:47], v[20:23]
    ds_read_b64_tr_b16 v[132:133], v250 offset:35840
    ds_read_b64_tr_b16 v[134:135], v250 offset:37888
    v_mfma_f32_16x16x32_bf16 v[24:27], v[136:139], v[44:47], v[24:27]
    ds_read_b64_tr_b16 v[136:137], v251 offset:35840
    ds_read_b64_tr_b16 v[138:139], v251 offset:37888
    v_mfma_f32_16x16x32_bf16 v[28:31], v[140:143], v[44:47], v[28:31]
    ds_read_b64_tr_b16 v[140:141], v252 offset:35840
    ds_read_b64_tr_b16 v[142:143], v252 offset:37888
    v_mfma_f32_16x16x32_bf16 v[32:35], v[144:147], v[44:47], v[32:35]
    ds_read_b64_tr_b16 v[144:145], v253 offset:35840
    ds_read_b64_tr_b16 v[146:147], v253 offset:37888
    s_waitcnt vmcnt(13)
    v_mfma_f32_16x16x32_bf16 v[20:23], v[148:151], v[48:51], v[20:23]
    ds_read_b64_tr_b16 v[148:149], v252 offset:39424
    ds_read_b64_tr_b16 v[150:151], v252 offset:41472
    v_mfma_f32_16x16x32_bf16 v[24:27], v[152:155], v[48:51], v[24:27]
    ds_read_b64_tr_b16 v[152:153], v253 offset:39424
    ds_read_b64_tr_b16 v[154:155], v253 offset:41472
    v_mfma_f32_16x16x32_bf16 v[28:31], v[156:159], v[48:51], v[28:31]
    ds_read_b64_tr_b16 v[156:157], v250 offset:39424
    ds_read_b64_tr_b16 v[158:159], v250 offset:41472
    v_mfma_f32_16x16x32_bf16 v[32:35], v[160:163], v[48:51], v[32:35]
    ds_read_b64_tr_b16 v[160:161], v251 offset:39424
    ds_read_b64_tr_b16 v[162:163], v251 offset:41472
    s_waitcnt vmcnt(12)
    v_mfma_f32_16x16x32_bf16 v[20:23], v[164:167], v[52:55], v[20:23]
    ds_read_b64_tr_b16 v[164:165], v250 offset:43008
    ds_read_b64_tr_b16 v[166:167], v250 offset:45056
    v_mfma_f32_16x16x32_bf16 v[24:27], v[168:171], v[52:55], v[24:27]
    ds_read_b64_tr_b16 v[168:169], v251 offset:43008
    ds_read_b64_tr_b16 v[170:171], v251 offset:45056
    v_mfma_f32_16x16x32_bf16 v[28:31], v[172:175], v[52:55], v[28:31]
    ds_read_b64_tr_b16 v[172:173], v252 offset:43008
    ds_read_b64_tr_b16 v[174:175], v252 offset:45056
    v_mfma_f32_16x16x32_bf16 v[32:35], v[176:179], v[52:55], v[32:35]
    ds_read_b64_tr_b16 v[176:177], v253 offset:43008
    ds_read_b64_tr_b16 v[178:179], v253 offset:45056
    s_waitcnt vmcnt(11)
    v_mfma_f32_16x16x32_bf16 v[20:23], v[180:183], v[56:59], v[20:23]
    ds_read_b64_tr_b16 v[180:181], v252 offset:46592
    ds_read_b64_tr_b16 v[182:183], v252 offset:48640
    v_mfma_f32_16x16x32_bf16 v[24:27], v[184:187], v[56:59], v[24:27]
    ds_read_b64_tr_b16 v[184:185], v253 offset:46592
    ds_read_b64_tr_b16 v[186:187], v253 offset:48640
    v_mfma_f32_16x16x32_bf16 v[28:31], v[188:191], v[56:59], v[28:31]
    ds_read_b64_tr_b16 v[188:189], v250 offset:46592
    ds_read_b64_tr_b16 v[190:191], v250 offset:48640
    v_mfma_f32_16x16x32_bf16 v[32:35], v[192:195], v[56:59], v[32:35]
    ds_read_b64_tr_b16 v[192:193], v251 offset:46592
    ds_read_b64_tr_b16 v[194:195], v251 offset:48640
    s_waitcnt vmcnt(10)
    v_mfma_f32_16x16x32_bf16 v[20:23], v[196:199], v[60:63], v[20:23]
    ds_read_b64_tr_b16 v[196:197], v250 offset:50176
    ds_read_b64_tr_b16 v[198:199], v250 offset:52224
    v_mfma_f32_16x16x32_bf16 v[24:27], v[200:203], v[60:63], v[24:27]
    ds_read_b64_tr_b16 v[200:201], v251 offset:50176
    ds_read_b64_tr_b16 v[202:203], v251 offset:52224
    v_mfma_f32_16x16x32_bf16 v[28:31], v[204:207], v[60:63], v[28:31]
    ds_read_b64_tr_b16 v[204:205], v252 offset:50176
    ds_read_b64_tr_b16 v[206:207], v252 offset:52224
    v_mfma_f32_16x16x32_bf16 v[32:35], v[208:211], v[60:63], v[32:35]
    ds_read_b64_tr_b16 v[208:209], v253 offset:50176
    ds_read_b64_tr_b16 v[210:211], v253 offset:52224
    s_waitcnt vmcnt(9)
    v_mfma_f32_16x16x32_bf16 v[20:23], v[212:215], v[64:67], v[20:23]
    ds_read_b64_tr_b16 v[212:213], v252 offset:53760
    ds_read_b64_tr_b16 v[214:215], v252 offset:55808
    v_mfma_f32_16x16x32_bf16 v[24:27], v[216:219], v[64:67], v[24:27]
    ds_read_b64_tr_b16 v[216:217], v253 offset:53760
    ds_read_b64_tr_b16 v[218:219], v253 offset:55808
    v_mfma_f32_16x16x32_bf16 v[28:31], v[220:223], v[64:67], v[28:31]
    ds_read_b64_tr_b16 v[220:221], v250 offset:53760
    ds_read_b64_tr_b16 v[222:223], v250 offset:55808
    v_mfma_f32_16x16x32_bf16 v[32:35], v[224:227], v[64:67], v[32:35]
    ds_read_b64_tr_b16 v[224:225], v251 offset:53760
    ds_read_b64_tr_b16 v[226:227], v251 offset:55808
    s_waitcnt vmcnt(8)
    s_waitcnt lgkmcnt(15)
    v_mfma_f32_16x16x32_bf16 v[20:23], v[100:103], v[68:71], v[20:23]
    v_mfma_f32_16x16x32_bf16 v[24:27], v[104:107], v[68:71], v[24:27]
    v_mfma_f32_16x16x32_bf16 v[28:31], v[108:111], v[68:71], v[28:31]
    v_mfma_f32_16x16x32_bf16 v[32:35], v[112:115], v[68:71], v[32:35]
    s_waitcnt vmcnt(7)
    v_mfma_f32_16x16x32_bf16 v[20:23], v[116:119], v[72:75], v[20:23]
    v_mfma_f32_16x16x32_bf16 v[24:27], v[120:123], v[72:75], v[24:27]
    v_mfma_f32_16x16x32_bf16 v[28:31], v[124:127], v[72:75], v[28:31]
    v_mfma_f32_16x16x32_bf16 v[32:35], v[128:131], v[72:75], v[32:35]
    s_waitcnt vmcnt(6)
    v_mfma_f32_16x16x32_bf16 v[20:23], v[132:135], v[76:79], v[20:23]
    v_mfma_f32_16x16x32_bf16 v[24:27], v[136:139], v[76:79], v[24:27]
    v_mfma_f32_16x16x32_bf16 v[28:31], v[140:143], v[76:79], v[28:31]
    v_mfma_f32_16x16x32_bf16 v[32:35], v[144:147], v[76:79], v[32:35]
    s_waitcnt vmcnt(5)
    v_mfma_f32_16x16x32_bf16 v[20:23], v[148:151], v[80:83], v[20:23]
    v_mfma_f32_16x16x32_bf16 v[24:27], v[152:155], v[80:83], v[24:27]
    v_mfma_f32_16x16x32_bf16 v[28:31], v[156:159], v[80:83], v[28:31]
    v_mfma_f32_16x16x32_bf16 v[32:35], v[160:163], v[80:83], v[32:35]
    s_waitcnt vmcnt(4)
    v_mfma_f32_16x16x32_bf16 v[20:23], v[164:167], v[84:87], v[20:23]
    v_mfma_f32_16x16x32_bf16 v[24:27], v[168:171], v[84:87], v[24:27]
    v_mfma_f32_16x16x32_bf16 v[28:31], v[172:175], v[84:87], v[28:31]
    v_mfma_f32_16x16x32_bf16 v[32:35], v[176:179], v[84:87], v[32:35]
    s_waitcnt vmcnt(3)
    v_mfma_f32_16x16x32_bf16 v[20:23], v[180:183], v[88:91], v[20:23]
    v_mfma_f32_16x16x32_bf16 v[24:27], v[184:187], v[88:91], v[24:27]
    v_mfma_f32_16x16x32_bf16 v[28:31], v[188:191], v[88:91], v[28:31]
    v_mfma_f32_16x16x32_bf16 v[32:35], v[192:195], v[88:91], v[32:35]
    s_waitcnt vmcnt(2)
    s_waitcnt lgkmcnt(14)
    v_mfma_f32_16x16x32_bf16 v[20:23], v[196:199], v[92:95], v[20:23]
    s_waitcnt lgkmcnt(12)
    v_mfma_f32_16x16x32_bf16 v[24:27], v[200:203], v[92:95], v[24:27]
    s_waitcnt lgkmcnt(10)
    v_mfma_f32_16x16x32_bf16 v[28:31], v[204:207], v[92:95], v[28:31]
    s_waitcnt lgkmcnt(8)
    v_mfma_f32_16x16x32_bf16 v[32:35], v[208:211], v[92:95], v[32:35]
    s_waitcnt vmcnt(1)
    s_waitcnt lgkmcnt(6)
    v_mfma_f32_16x16x32_bf16 v[20:23], v[212:215], v[96:99], v[20:23]
    s_waitcnt lgkmcnt(4)
    v_mfma_f32_16x16x32_bf16 v[24:27], v[216:219], v[96:99], v[24:27]
    s_waitcnt lgkmcnt(2)
    v_mfma_f32_16x16x32_bf16 v[28:31], v[220:223], v[96:99], v[28:31]
    s_waitcnt lgkmcnt(0)
    v_mfma_f32_16x16x32_bf16 v[32:35], v[224:227], v[96:99], v[32:35]
    s_waitcnt vmcnt(0)
    s_nop 3
    v_sub_f32 v4, v4, v20
    v_sub_f32 v5, v5, v21
    v_sub_f32 v6, v6, v22
    v_sub_f32 v7, v7, v23
    v_fma_f32 v4, v4, v234, v20
    v_fma_f32 v5, v5, v234, v21
    v_fma_f32 v6, v6, v234, v22
    v_fma_f32 v7, v7, v234, v23
    v_cvt_pk_bf16_f32 v36, v4, v5
    v_cvt_pk_bf16_f32 v37, v6, v7
    ds_write_b64 v245, v[36:37] offset:0
    v_sub_f32 v8, v8, v24
    v_sub_f32 v9, v9, v25
    v_sub_f32 v10, v10, v26
    v_sub_f32 v11, v11, v27
    v_fma_f32 v8, v8, v234, v24
    v_fma_f32 v9, v9, v234, v25
    v_fma_f32 v10, v10, v234, v26
    v_fma_f32 v11, v11, v234, v27
    v_cvt_pk_bf16_f32 v38, v8, v9
    v_cvt_pk_bf16_f32 v39, v10, v11
    ds_write_b64 v245, v[38:39] offset:32
    v_sub_f32 v12, v12, v28
    v_sub_f32 v13, v13, v29
    v_sub_f32 v14, v14, v30
    v_sub_f32 v15, v15, v31
    v_fma_f32 v12, v12, v234, v28
    v_fma_f32 v13, v13, v234, v29
    v_fma_f32 v14, v14, v234, v30
    v_fma_f32 v15, v15, v234, v31
    v_cvt_pk_bf16_f32 v40, v12, v13
    v_cvt_pk_bf16_f32 v41, v14, v15
    ds_write_b64 v245, v[40:41] offset:64
    v_sub_f32 v16, v16, v32
    v_sub_f32 v17, v17, v33
    v_sub_f32 v18, v18, v34
    v_sub_f32 v19, v19, v35
    v_fma_f32 v16, v16, v234, v32
    v_fma_f32 v17, v17, v234, v33
    v_fma_f32 v18, v18, v234, v34
    v_fma_f32 v19, v19, v234, v35
    v_cvt_pk_bf16_f32 v42, v16, v17
    v_cvt_pk_bf16_f32 v43, v18, v19
    ds_write_b64 v245, v[42:43] offset:96
    s_waitcnt lgkmcnt(0)
    ds_read_b128 v[44:47], v246
    ds_read_b128 v[48:51], v246 offset:1152
    s_mov_b32 s44, 7168
    s_waitcnt lgkmcnt(1)
    buffer_store_dwordx4 v[44:47], v249, s[28:31], 0 offen
    s_waitcnt lgkmcnt(0)
    buffer_store_dwordx4 v[48:51], v249, s[28:31], s44 offen
    s_endpgm
L_idle2:
    s_cmp_lg_u32 s39, 15
    s_cbranch_scc1 L_end
    v_lshlrev_b32 v10, 5, v0
    s_mov_b32 s64, 0
L_jan:
    s_mov_b32 s44, 65536
    buffer_load_dwordx2 v[12:13], v10, s[16:19], s44 offen sc1
    s_mov_b32 s44, 81920
    buffer_load_dwordx2 v[14:15], v10, s[16:19], s44 offen sc1
    s_mov_b32 s44, 98304
    buffer_load_dwordx2 v[16:17], v10, s[16:19], s44 offen sc1
    s_mov_b32 s44, 114688
    buffer_load_dwordx2 v[18:19], v10, s[16:19], s44 offen sc1
    s_add_u32 s64, s64, 1
    s_waitcnt vmcnt(0)
    v_cmp_ne_u64 s[44:45], s[42:43], v[12:13]
    v_cmp_ne_u64 s[46:47], s[42:43], v[14:15]
    s_or_b64 s[44:45], s[44:45], s[46:47]
    v_cmp_ne_u64 s[46:47], s[42:43], v[16:17]
    s_or_b64 s[44:45], s[44:45], s[46:47]
    v_cmp_ne_u64 s[46:47], s[42:43], v[18:19]
    s_or_b64 s[44:45], s[44:45], s[46:47]
    s_cbranch_scc0 L_jand
    s_cmp_gt_u32 s64, 0x40000
    s_cbranch_scc1 L_jand
    s_sleep 4
    s_branch L_jan
L_jand:
    s_barrier
    s_cmp_lg_u32 s36, 0
    s_cbranch_scc1 L_end
    s_mov_b32 s44, 0
    v_mov_b32 v10, s42
    v_mov_b32 v11, s43
    s_mov_b64 exec, 1
    buffer_store_dwordx2 v[10:11], off, s[16:19], s44 sc1
    s_mov_b64 exec, -1
L_end:
    s_endpgm
.section .rodata,"a"
.p2align 6
.amdhsa_kernel gated_mix__sliding_local_dilated__linear_attn_block__prompt_kernel
  .amdhsa_next_free_vgpr 256
  .amdhsa_next_free_sgpr 102
  .amdhsa_accum_offset 256
  .amdhsa_group_segment_fixed_size 0
  .amdhsa_kernarg_size 80
  .amdhsa_user_sgpr_count 2
  .amdhsa_user_sgpr_kernarg_segment_ptr 1
  .amdhsa_system_sgpr_workgroup_id_x 1
.end_amdhsa_kernel
```
